```python
import torch

def _softmax(x, axis=-1):
    return torch.softmax(x, dim=axis)
def _gelu(x):
    return torch.nn.functional.gelu(x, approximate="tanh")
def _silu(x):
    return torch.nn.functional.silu(x)
def _sigmoid(x):
    return torch.sigmoid(x)
def _layernorm(x, axis=-1, eps=1e-5):
    m = x.mean(dim=axis, keepdim=True)
    v = x.var(dim=axis, keepdim=True, unbiased=False)
    return (x - m) / torch.sqrt(v + eps)
def _scatter_add(tgt, idx, src, axis=0):
    return tgt.clone().index_add_(axis, idx, src)
def _segment_sum(src, seg, n):
    out = torch.zeros((n,) + src.shape[1:], dtype=src.dtype)
    return out.index_add_(0, seg, src)
def _pad(x, pw):
    flat = tuple(v for pair in reversed(pw) for v in pair)
    return torch.nn.functional.pad(x, flat)

kernel_name = 'standalone__sequential_behavior_din__recsys'

def setup_inputs():

    _w = (lambda a: (lambda t: t.to(torch.bfloat16) if t.is_floating_point() else t)(torch.as_tensor(a)))
    B, L, D = 16384, 20, 64
    H = D
    return {
        "target": _w((lambda *s: torch.randn(*s, dtype=torch.bfloat16) * 1.6)(B, D)),
        "hist": _w((lambda *s: torch.randn(*s, dtype=torch.bfloat16) * 1.6)(B, L, D)),
        "mask": _w((lambda lo, hi, *s: torch.randint(lo, hi, s))(0, 2, B, L).to(float)),
        "w1": _w((lambda *s: torch.randn(*s, dtype=torch.bfloat16) * 1.6)(4 * D, H) * (4 * D) ** -0.5),
        "b1": _w((lambda *s: torch.randn(*s, dtype=torch.bfloat16) * 12.8)(H) * 0.1),
        "w2": _w((lambda *s: torch.randn(*s, dtype=torch.bfloat16) * 0.05)(H, 1) * H ** -0.5),
        "b2": _w((lambda *s: torch.randn(*s, dtype=torch.bfloat16) * 0.2)(1) * 0.1),
    }

def reference(target, hist, mask, w1, b1, w2, b2):
    L = hist.shape[1]
    tgt = (lambda x, n, axis: torch.repeat_interleave(x, n, dim=axis))(target[:, None, :], L, axis=1)
    feat = torch.concatenate([hist, tgt, hist - tgt, hist * tgt], axis=-1)
    h = _sigmoid(feat @ w1 + b1)
    scores = (h @ w2 + b2)[..., 0] * mask
    return torch.einsum('bl,bld->bd', scores, hist)
```

```asm
; @launch grid=(256,1,1) block=(512,1,1) lds=160064
.amdgcn_target "amdgcn-amd-amdhsa--gfx950"
.text
.globl standalone__sequential_behavior_din__recsys_kernel
.p2align 12
.p2align 8
.type standalone__sequential_behavior_din__recsys_kernel,@function
standalone__sequential_behavior_din__recsys_kernel:
    s_load_dwordx16 s[4:19], s[0:1], 0
    v_lshrrev_b32 v121, 6, v0
    s_cmp_ge_u32 s2, 256
    s_cbranch_scc1 L_end
    v_readfirstlane_b32 s3, v121
    v_and_b32_e64 v120, 63, v0
    s_mov_b32 s36, 0xffff0000
    s_mov_b32 s38, 0xbfb8aa3b
    s_cmp_lt_u32 s3, 4
    s_cbranch_scc0 L_help
L_main:
    s_lshl2_add_u32 s20, s2, s3
    s_mul_i32 s50, s20, 640
    v_lshl_add_u32 v56, v120, 1, s50
    s_mul_i32 s21, s3, 33488
    s_add_u32 s21, s21, 26112
    v_bfe_u32 v124, v120, 4, 1
    v_and_b32 v125, 7, v120
    v_xor_b32 v124, v124, v125
    v_lshlrev_b32 v3, 4, v124
    v_lshrrev_b32 v125, 3, v120
    v_lshl_add_u32 v126, v125, 7, v3
    s_lshl_b32 s51, s20, 11
    v_add_u32 v57, s51, v126
    s_add_u32 m0, s21, 2048
    s_setprio 2
    s_waitcnt lgkmcnt(0)
    global_load_ushort v40, v56, s[8:9] offset:0 nt
    global_load_ushort v41, v56, s[8:9] offset:128 nt
    global_load_ushort v42, v56, s[8:9] offset:256 nt
    global_load_ushort v43, v56, s[8:9] offset:384 nt
    global_load_ushort v44, v56, s[8:9] offset:512 nt
    s_barrier
    v_lshl_add_u32 v7, v125, 4, s21
    v_mov_b32 v104, 0xffc0
    v_mov_b32 v105, v104
    v_mov_b32 v106, v104
    v_mov_b32 v107, v104
    v_lshl_add_u32 v114, v120, 4, s21
    v_mov_b32 v160, 0
    v_mov_b32 v161, 0
    v_mov_b32 v162, 0
    v_mov_b32 v163, 0
    v_lshlrev_b32 v58, 2, v120
    v_lshrrev_b32 v122, 2, v120
    v_and_b32 v123, 3, v120
    v_lshlrev_b32 v123, 1, v123
    v_sub_u32 v122, v122, v123
    global_load_lds_dwordx4 v57, s[4:5] nt
    s_addk_i32 m0, 32
    s_nop 0
    global_load_lds_dwordx4 v57, s[4:5] offset:1024 nt
    s_branch L_main2
L_help:
    s_getpc_b64 s[70:71]
    s_lshr_b32 s73, s2, 3
    s_xor_b32 s73, s73, s2
    s_and_b32 s73, s73, 31
    s_lshl2_add_u32 s73, s73, s3
    s_lshl_b32 s73, s73, 7
    s_add_u32 s70, s70, s73
    s_addc_u32 s71, s71, 0
    v_mov_b32 v134, s70
    v_mov_b32 v135, s71
    v_lshlrev_b32 v131, 2, v120
    v_and_b32 v0, 0xff, v0
    s_mov_b64 exec, 1
    global_load_dword v132, v[134:135], off
    s_mov_b64 exec, -1
    s_bfe_u32 s76, s2, 0x10003
    s_lshl_b32 s77, s76, 12
    v_lshl_add_u32 v120, v0, 4, s77
    v_add_u32 v121, 0x2000, v120
    v_add_u32 v122, 0x4000, v120
    v_add_u32 v123, 0x6000, v120
    s_and_b32 s49, s3, 1
    s_lshl_b32 s67, s49, 7
    s_add_u32 m0, s67, 25600
    s_cmp_eq_u32 s49, 0
    s_waitcnt lgkmcnt(0)
    s_cselect_b32 s12, s12, s14
    s_cselect_b32 s13, s13, s15
    s_barrier
    global_load_dwordx4 v[36:39], v123, s[10:11]
    global_load_dwordx4 v[32:35], v122, s[10:11]
    global_load_dwordx4 v[28:31], v121, s[10:11]
    global_load_dwordx4 v[24:27], v120, s[10:11]
    s_mov_b32 exec_hi, 0
    global_load_lds_dword v131, s[12:13]
    s_mov_b32 m0, 25856
    s_mov_b32 exec_lo, 1
    global_load_lds_ushort v131, s[16:17]
    s_mov_b64 exec, -1
    v_xor_b32 v124, 0x1000, v120
    v_xor_b32 v125, 0x1000, v121
    v_xor_b32 v126, 0x1000, v122
    v_xor_b32 v127, 0x1000, v123
    v_lshrrev_b32 v130, 3, v0
    v_and_b32 v134, 3, v0
    v_bfe_u32 v133, v0, 2, 1
    s_movk_i32 s77, 4160
    v_mul_u32_u24 v133, s77, v133
    v_lshl_add_u32 v133, v130, 6, v133
    v_lshl_add_u32 v133, v134, 4, v133
    s_lshl_b32 s77, s76, 11
    v_add_u32 v128, s77, v133
    s_xor_b32 s77, s77, 0x800
    v_add_u32_e64 v129, s77, v133
    global_load_dwordx4 v[52:55], v127, s[10:11]
    s_mul_i32 s21, s3, 33488
    s_add_u32 s21, s21, -107840
    v_and_b32 v130, 63, v0
    global_load_dwordx4 v[48:51], v126, s[10:11]
    v_lshrrev_b32 v134, 4, v130
    v_add_u32 v130, v130, v134
    v_lshl_add_u32 v130, v130, 4, s21
    global_load_dwordx4 v[44:47], v125, s[10:11]
    v_add_u32 v131, s21, v131
    v_mov_b32 v116, 0
    v_mov_b32 v117, 0
    global_load_dwordx4 v[40:43], v124, s[10:11]
    v_mov_b32 v118, 0
    v_mov_b32 v119, 0
    ds_write_b32 v131, v116 offset:8576
    ds_write_b128 v130, v[116:119] offset:8848
    ds_write_b128 v130, v[116:119] offset:9936
    ds_write_b128 v130, v[116:119] offset:11024
    ds_write_b128 v130, v[116:119] offset:12112
    ds_write_b128 v130, v[116:119] offset:13200
    ds_write_b128 v130, v[116:119] offset:14288
    ds_write_b128 v130, v[116:119] offset:15376
    ds_write_b128 v130, v[116:119] offset:16464
    ds_write_b128 v130, v[116:119] offset:17552
    ds_write_b128 v130, v[116:119] offset:18640
    ds_write_b128 v130, v[116:119] offset:19728
    s_setprio 1
    s_branch L_page
L_main2:
    s_mul_i32 s48, s20, 40960
    s_mov_b32 s22, 0xff80
    s_mov_b32 s33, 52429
    s_movk_i32 s35, 1056
    s_movk_i32 s79, 0x7c
    s_movk_i32 s37, 68
    s_add_u32 s34, s21, 20816
    s_mov_b32 s26, 40960
    s_mov_b32 s27, 0x20000
    s_mov_b32 s30, 42016
    s_mov_b32 s31, 0x20000
    s_mov_b32 s42, 43072
    s_mov_b32 s43, 0x20000
    s_mov_b32 s46, 44128
    s_mov_b32 s47, 0x20000
    s_add_u32 s24, s6, s48
    s_addc_u32 s25, s7, 0
    s_sub_u32 s28, s24, 1056
    s_subb_u32 s29, s25, 0
    s_sub_u32 s40, s24, 2112
    s_subb_u32 s41, s25, 0
    s_sub_u32 s44, s24, 3168
    s_subb_u32 s45, s25, 0
    v_mov_b32 v124, 0x3f80
    v_mov_b32 v125, 0x3f800000
    v_cmp_eq_u32 vcc, 8, v122
    v_cmp_eq_u32_e64 s[68:69], 9, v122
    v_mov_b32 v18, 0
    v_cndmask_b32 v123, v160, v124, vcc
    v_cndmask_b32_e64 v123, v123, v125, s[68:69]
    v_mfma_f32_32x32x16_bf16 v[136:151], v[160:163], v[160:163], 0
    ds_write_b128 v114, v[104:107] offset:0
    ds_write_b128 v114, v[104:107] offset:1024
    ds_write2st64_b32 v58, v123, v160 offset0:98 offset1:99
    v_bfe_u32 v121, v120, 3, 2
    v_lshrrev_b32 v122, 1, v121
    v_xor_b32 v122, v122, v121
    v_and_b32 v122, 1, v122
    v_lshlrev_b32 v122, 2, v122
    v_and_b32 v123, 7, v120
    v_xor_b32 v122, v122, v123
    v_lshrrev_b32 v123, 5, v120
    v_bfe_u32 v124, v122, 1, 1
    v_xor_b32 v124, v124, v123
    v_lshl_add_u32 v124, v124, 4, s34
    v_lshl_add_u32 v124, v122, 7, v124
    v_mad_u32_u24 v4, v121, s35, v124
    v_lshl_add_u32 v124, v122, 2, v121
    v_lshl_add_u32 v6, v124, 2, s21
    v_lshlrev_b32_e64 v124, 7, v123
    v_sub_u32 v8, 25216, v124
    v_lshl_add_u32 v11, v123, 4, s21
    v_and_or_b32 v124, v122, 4, v121
    v_and_b32 v125, 3, v122
    v_mul_u32_u24 v125, 0x110, v125
    v_lshl_add_u32 v125, v124, 1, v125
    v_add_u32 v9, s21, v125
    v_lshrrev_b32 v121, 4, v120
    v_lshl_add_u32 v10, v121, 4, v114
    v_bfe_u32 v122, v120, 2, 2
    v_and_b32 v123, 3, v120
    v_lshrrev_b32 v124, 5, v120
    v_lshlrev_b32 v125, 1, v124
    v_xor_b32_e64 v125, v123, v125
    v_lshl_add_u32 v125, v125, 3, s34
    v_lshl_add_u32 v125, v121, 7, v125
    v_mad_u32_u24 v5, v122, s35, v125
    v_and_b32 v121, 1, v121
    v_lshl_add_u32 v125, v124, 3, v122
    v_lshlrev_b32 v125, 6, v125
    v_and_b32 v126, 1, v123
    v_lshl_add_u32 v125, v126, 5, v125
    v_lshl_add_u32 v112, v121, 1, v126
    v_lshrrev_b32 v126, 1, v123
    v_lshl_add_u32 v20, v121, 1, v126
    v_lshl_add_u32 v20, v20, 3, v125
    v_lshrrev_b32 v113, 1, v122
    v_xor_b32 v112, v112, v113
    s_add_u32 s68, s21, 2048
    v_lshl_add_u32 v112, v112, 4, s68
    v_lshl_add_u32 v112, v126, 3, v112
    v_lshl_add_u32 v112, v122, 7, v112
    v_mad_u32_u24 v112, v124, s35, v112
    v_cmp_eq_u32_e64 s[80:81], 0, v121
    v_and_b32 v125, 1, v122
    v_xor_b32 v121, v121, v125
    v_or_b32 v121, v121, v123
    v_lshlrev_b32 v22, 5, v124
    v_add_u32 v22, 25728, v22
    v_cmp_eq_u32 vcc, 0, v121
    v_mov_b32 v23, 25088
    v_xor_b32_e64 v126, v126, v124
    v_cndmask_b32 v22, v23, v22, vcc
    v_lshl_add_u32 v121, v113, 2, v123
    v_lshl_add_u32 v126, v126, 4, s68
    v_lshl_add_u32 v126, v121, 7, v126
    v_mad_u32_u24 v113, v125, s35, v126
    v_cndmask_b32_e64 v113, v23, v113, s[80:81]
    v_bfe_u32 v121, v120, 3, 2
    v_lshl_add_u32 v121, v121, 2, v123
    v_lshl_add_u32 v121, v125, 4, v121
    v_lshlrev_b32 v21, 1, v121
    s_lshr_b32 s32, s21, 2
    s_add_u32 s32, s32, 320
    v_mul_u32_u24 v121, s33, v120
    v_lshlrev_b32 v122, 7, v120
    v_lshrrev_b32_e64 v123, 18, v121
    v_and_or_b32 v48, v123, 60, v122
    v_add_u32 v121, 3355456, v121
    v_add_u32 v122, 0x2000, v122
    v_lshrrev_b32_e64 v123, 18, v121
    v_and_or_b32 v49, v123, 60, v122
    v_add_u32 v121, 3355456, v121
    v_add_u32 v122, 0x2000, v122
    v_lshrrev_b32_e64 v123, 18, v121
    v_and_or_b32 v50, v123, 60, v122
    v_add_u32 v121, 3355456, v121
    v_add_u32 v122, 0x2000, v122
    v_lshrrev_b32_e64 v123, 18, v121
    v_and_or_b32 v51, v123, 60, v122
    v_add_u32 v121, 3355456, v121
    v_add_u32 v122, 0x2000, v122
    v_lshrrev_b32_e64 v123, 18, v121
    v_and_or_b32 v52, v123, 60, v122
    s_sub_u32 s74, s32, 160
    s_add_u32 m0, s34, 4224
    s_waitcnt vmcnt(2) lgkmcnt(0)
    v_cmp_ne_u32_e64 s[52:53], 0, v40
    v_cmp_ne_u32_e64 s[54:55], 0, v41
    v_cmp_ne_u32_e64 s[56:57], 0, v42
    v_cmp_ne_u32_e64 s[58:59], 0, v43
    v_cmp_ne_u32_e64 s[60:61], 0, v44
    v_lshl_or_b32 v48, v40, 16, v48
    v_lshl_or_b32 v49, v41, 16, v49
    s_bcnt1_i32_b64 s62, s[52:53]
    s_bcnt1_i32_b64 s63, s[54:55]
    s_bcnt1_i32_b64 s64, s[56:57]
    s_bcnt1_i32_b64 s65, s[58:59]
    s_bcnt1_i32_b64 s66, s[60:61]
    s_sub_u32 s66, s32, s66
    s_sub_u32 s65, s66, s65
    s_sub_u32 s64, s65, s64
    s_sub_u32 s63, s64, s63
    s_sub_u32 s62, s63, s62
    v_mbcnt_lo_u32_b32 v56, s52, 0
    v_mbcnt_lo_u32_b32 v57, s54, 0
    v_mbcnt_hi_u32_b32 v56, s53, v56
    v_mbcnt_hi_u32_b32 v57, s55, v57
    v_add_lshl_u32 v56, v56, s62, 2
    v_add_lshl_u32 v57, v57, s63, 2
    s_sub_u32 s23, s62, s32
    s_mov_b64 exec, s[52:53]
    ds_write_b32 v56, v48
    s_mov_b64 exec, s[54:55]
    ds_write_b32 v57, v49
    s_mov_b64 exec, -1
    ds_read_b128 v[160:163], v7 offset:512
    s_add_u32 s23, s23, 320
    s_lshr_b32 s23, s23, 5
    s_min_u32 s23, s23, 9
    s_cmp_ge_u32 s64, s74
    s_cselect_b32 s77, 4, 15
    v_mbcnt_lo_u32_b32 v58, s56, 0
    v_mbcnt_lo_u32_b32 v59, s58, 0
    v_mbcnt_lo_u32_b32 v60, s60, 0
    v_mbcnt_hi_u32_b32 v58, s57, v58
    v_mbcnt_hi_u32_b32 v59, s59, v59
    v_mbcnt_hi_u32_b32 v60, s61, v60
    v_lshl_or_b32 v50, v42, 16, v50
    v_lshl_or_b32 v51, v43, 16, v51
    v_lshl_or_b32 v52, v44, 16, v52
    s_cmp_lg_u32 s77, s23
    s_waitcnt lgkmcnt(0)
    v_and_or_b32 v160, v160, s22, v3
    v_and_or_b32 v161, v161, s22, v3
    v_and_or_b32 v162, v162, s22, v3
    v_and_or_b32 v163, v163, s22, v3
    s_cbranch_scc1 L_nq
    buffer_load_dwordx4 v160, s[24:27], 0 offen offset:0 nt lds
    buffer_load_dwordx4 v161, s[28:31], 0 offen offset:1056 nt lds
    buffer_load_dwordx4 v162, s[40:43], 0 offen offset:2112 nt lds
    buffer_load_dwordx4 v163, s[44:47], 0 offen offset:3168 nt lds
L_nq:
    s_cselect_b32 s77, s23, 15
    s_setprio 0
    v_add_lshl_u32 v58, v58, s64, 2
    v_add_lshl_u32 v59, v59, s65, 2
    v_add_lshl_u32 v60, v60, s66, 2
    s_lshl_b32 s49, s23, 7
    v_add_u32 v121, s49, v7
    v_add_u32 v122, s49, v6
    s_lshl_b32 s50, s23, 1
    s_mov_b64 exec, s[56:57]
    ds_write_b32 v58, v50
    s_mov_b64 exec, s[58:59]
    ds_write_b32 v59, v51
    s_mov_b64 exec, s[60:61]
    ds_write_b32 v60, v52
    s_mov_b64 exec, -1
    ds_read_b128 v[160:163], v121
    ds_read_b128 v[152:155], v121 offset:128
    ds_read_b32 v12, v122
    s_lshr_b32 s75, 0x924924, s50
    s_and_b32 s50, s75, 3
    s_mul_i32 s39, s50, 4224
    s_add_u32 s72, s34, s39
    s_bfe_u32 s50, s75, 0x20002
    s_mul_i32 s73, s50, 4224
    s_add_u32 s73, s73, s34
    s_mov_b32 m0, s72
    s_cmp_gt_u32 s77, 4
    s_waitcnt lgkmcnt(2)
    v_and_or_b32 v160, v160, s22, v3
    v_and_or_b32 v161, v161, s22, v3
    v_and_or_b32 v162, v162, s22, v3
    v_and_or_b32 v163, v163, s22, v3
    s_cbranch_scc1 L_sA
    buffer_load_dwordx4 v160, s[24:27], 0 offen offset:0 nt lds
    buffer_load_dwordx4 v161, s[28:31], 0 offen offset:1056 nt lds
    buffer_load_dwordx4 v162, s[40:43], 0 offen offset:2112 nt lds
    buffer_load_dwordx4 v163, s[44:47], 0 offen offset:3168 nt lds
L_sA:
    s_waitcnt lgkmcnt(0)
    v_and_b32 v14, s79, v12
    v_lshl_add_u32 v16, v14, 2, v8
    v_mov_b32 v13, v12
    v_mov_b32_e64 v15, v14
    v_and_or_b32 v152, v152, s22, v3
    v_and_or_b32 v153, v153, s22, v3
    v_and_or_b32 v154, v154, s22, v3
    v_and_or_b32 v155, v155, s22, v3
    ds_read_b128 a[80:83], v16
    s_waitcnt vmcnt(4)
    s_cmp_le_u32 s23, 4
    s_cbranch_scc1 L_tw
    s_waitcnt vmcnt(0)
L_tw:
    ds_read_b64_tr_b16 v[164:165], v112 offset:0
    ds_read_b64_tr_b16 v[166:167], v112 offset:512
    ds_read_b64_tr_b16 v[168:169], v112 offset:64
    ds_read_b64_tr_b16 v[170:171], v112 offset:576
    ds_read_b128 a[16:19], v113 offset:0
    ds_read_b128 a[20:23], v113 offset:32
    ds_read_b128 a[24:27], v113 offset:64
    ds_read_b128 a[28:31], v113 offset:96
    s_cmp_gt_u32 s23, 4
    s_cbranch_scc1 L_sB
    s_mov_b32 m0, s73
    s_nop 0
    buffer_load_dwordx4 v152, s[24:27], 0 offen offset:0 nt lds
    buffer_load_dwordx4 v153, s[28:31], 0 offen offset:1056 nt lds
    buffer_load_dwordx4 v154, s[40:43], 0 offen offset:2112 nt lds
    buffer_load_dwordx4 v155, s[44:47], 0 offen offset:3168 nt lds
L_sB:
    s_waitcnt lgkmcnt(4)
    v_mfma_f32_32x32x16_bf16 v[72:87], v[164:167], a[80:83], 0
    v_mfma_f32_32x32x16_bf16 v[88:103], v[168:171], a[80:83], 0
    s_cmp_eq_u32 s23, 4
    s_cbranch_scc1 L_fused
    s_barrier
    s_cmp_le_u32 s23, 4
    s_cbranch_scc1 L_sC
    s_mov_b32 m0, s72
    s_nop 0
    buffer_load_dwordx4 v160, s[24:27], 0 offen offset:0 nt lds
    buffer_load_dwordx4 v161, s[28:31], 0 offen offset:1056 nt lds
    buffer_load_dwordx4 v162, s[40:43], 0 offen offset:2112 nt lds
    buffer_load_dwordx4 v163, s[44:47], 0 offen offset:3168 nt lds
L_sC:
    ds_read_u16 v158, v21 offset:25600
    ds_read_u16 v159, v21 offset:25664
    ds_read_u16 v2, v18 offset:25856
    ds_read_b64_tr_b16 v[40:41], v20 offset:16640
    ds_read_b64_tr_b16 v[42:43], v20 offset:16896
    ds_read_b64_tr_b16 v[44:45], v20 offset:17664
    ds_read_b64_tr_b16 v[46:47], v20 offset:17920
    ds_read_b64_tr_b16 v[48:49], v20 offset:18688
    ds_read_b64_tr_b16 v[50:51], v20 offset:18944
    ds_read_b64_tr_b16 v[52:53], v20 offset:19712
    ds_read_b64_tr_b16 v[54:55], v20 offset:19968
    ds_read_b64_tr_b16 v[56:57], v20 offset:20800
    ds_read_b64_tr_b16 v[58:59], v20 offset:21056
    ds_read_b64_tr_b16 v[60:61], v20 offset:21824
    ds_read_b64_tr_b16 v[62:63], v20 offset:22080
    s_waitcnt lgkmcnt(12)
    v_lshlrev_b32 v158, 16, v158
    v_lshlrev_b32 v159, 16, v159
    v_lshlrev_b32 v2, 16, v2
    v_pk_mul_f32 v[104:105], v[158:159], s[38:39] op_sel:[0,0] op_sel_hi:[0,0]
    v_pk_mul_f32 v[106:107], v[158:159], s[38:39] op_sel:[0,0] op_sel_hi:[0,0]
    v_pk_mul_f32 v[108:109], v[158:159], s[38:39] op_sel:[0,0] op_sel_hi:[0,0]
    v_pk_mul_f32 v[110:111], v[158:159], s[38:39] op_sel:[0,0] op_sel_hi:[0,0]
    v_pk_mul_f32 v[120:121], v[158:159], s[38:39] op_sel:[1,0] op_sel_hi:[1,0]
    v_pk_mul_f32 v[122:123], v[158:159], s[38:39] op_sel:[1,0] op_sel_hi:[1,0]
    v_pk_mul_f32 v[124:125], v[158:159], s[38:39] op_sel:[1,0] op_sel_hi:[1,0]
    v_pk_mul_f32 v[126:127], v[158:159], s[38:39] op_sel:[1,0] op_sel_hi:[1,0]
    s_waitcnt lgkmcnt(0)
    v_mfma_f32_32x32x16_bf16 v[104:119], a[16:19], v[40:43], v[104:119]
    ds_read_b64_tr_b16 v[64:65], v20 offset:22848
    ds_read_b64_tr_b16 v[66:67], v20 offset:23104
    ds_read_b64_tr_b16 v[68:69], v20 offset:23872
    ds_read_b64_tr_b16 v[70:71], v20 offset:24128
    v_mfma_f32_32x32x16_bf16 v[104:119], a[20:23], v[44:47], v[104:119]
    v_mfma_f32_32x32x16_bf16 v[104:119], a[24:27], v[48:51], v[104:119]
    v_mfma_f32_32x32x16_bf16 v[104:119], a[28:31], v[52:55], v[104:119]
    s_cmp_le_u32 s23, 4
    s_cbranch_scc1 L_sD
    s_mov_b32 m0, s73
    s_nop 0
    buffer_load_dwordx4 v152, s[24:27], 0 offen offset:0 nt lds
    buffer_load_dwordx4 v153, s[28:31], 0 offen offset:1056 nt lds
    buffer_load_dwordx4 v154, s[40:43], 0 offen offset:2112 nt lds
    buffer_load_dwordx4 v155, s[44:47], 0 offen offset:3168 nt lds
L_sD:
    v_mfma_f32_32x32x16_bf16 v[120:135], a[16:19], v[56:59], v[120:135]
    v_mfma_f32_32x32x16_bf16 v[120:135], a[20:23], v[60:63], v[120:135]
    s_waitcnt lgkmcnt(2)
    v_mfma_f32_32x32x16_bf16 v[120:135], a[24:27], v[64:67], v[120:135]
    s_waitcnt lgkmcnt(0)
    v_mfma_f32_32x32x16_bf16 v[120:135], a[28:31], v[68:71], v[120:135]
    ds_read_b64_tr_b16 a[0:1], v20 offset:0
    ds_read_b64_tr_b16 a[2:3], v20 offset:256
    ds_read_b64_tr_b16 a[4:5], v20 offset:1024
    ds_read_b64_tr_b16 a[6:7], v20 offset:1280
    ds_read_b64_tr_b16 a[8:9], v20 offset:2048
    ds_read_b64_tr_b16 a[10:11], v20 offset:2304
    ds_read_b64_tr_b16 a[12:13], v20 offset:3072
    ds_read_b64_tr_b16 a[14:15], v20 offset:3328
    ds_read_b64_tr_b16 a[32:33], v20 offset:8320
    ds_read_b64_tr_b16 a[34:35], v20 offset:8576
    ds_read_b64_tr_b16 a[36:37], v20 offset:9344
    ds_read_b64_tr_b16 a[38:39], v20 offset:9600
    ds_read_b64_tr_b16 a[40:41], v20 offset:10368
    ds_read_b64_tr_b16 a[42:43], v20 offset:10624
    ds_read_b64_tr_b16 a[44:45], v20 offset:11392
    ds_read_b64_tr_b16 a[46:47], v20 offset:11648
    ds_read_b64_tr_b16 a[48:49], v20 offset:12480
    ds_read_b64_tr_b16 a[50:51], v20 offset:12736
    ds_read_b64_tr_b16 a[52:53], v20 offset:13504
    ds_read_b64_tr_b16 a[54:55], v20 offset:13760
    ds_read_b64_tr_b16 a[56:57], v20 offset:14528
    ds_read_b64_tr_b16 a[58:59], v20 offset:14784
    ds_read_b64_tr_b16 a[60:61], v20 offset:15552
    ds_read_b64_tr_b16 a[62:63], v20 offset:15808
    ds_read_b128 a[64:67], v22 offset:0
    ds_read_b128 a[68:71], v22 offset:16
    ds_read_b128 a[72:75], v22 offset:64
    ds_read_b128 a[76:79], v22 offset:80
    ds_read_b64_tr_b16 a[16:17], v20 offset:4160
    ds_read_b64_tr_b16 a[18:19], v20 offset:4416
    ds_read_b64_tr_b16 a[20:21], v20 offset:5184
    ds_read_b64_tr_b16 a[22:23], v20 offset:5440
    ds_read_b64_tr_b16 a[24:25], v20 offset:6208
    ds_read_b64_tr_b16 a[26:27], v20 offset:6464
    ds_read_b64_tr_b16 a[28:29], v20 offset:7232
    ds_read_b64_tr_b16 a[30:31], v20 offset:7488
    v_cvt_pk_bf16_f32 v152, v104, v105
    v_cvt_pk_bf16_f32 v153, v106, v107
    v_cvt_pk_bf16_f32 v154, v108, v109
    v_cvt_pk_bf16_f32 v155, v110, v111
    v_cvt_pk_bf16_f32 v156, v120, v121
    v_cvt_pk_bf16_f32 v157, v122, v123
    v_cvt_pk_bf16_f32 v158, v124, v125
    v_cvt_pk_bf16_f32 v159, v126, v127
    s_cmp_eq_u32 s23, 5
    v_mfma_f32_32x32x16_bf16 v[104:119], v[152:155], a[80:83], 0
    s_cbranch_scc1 L_e5
    s_branch L_rare
.p2align 12
L_page:
    v_and_b32 v136, 63, v0
    v_lshrrev_b32 v137, 3, v136
    v_mul_u32_u24 v137, 272, v137
    v_bfe_u32 v138, v136, 4, 1
    v_xor_b32 v138, v138, v136
    v_and_b32 v138, 7, v138
    v_lshl_add_u32 v137, v138, 4, v137
    v_add_u32 v137, s21, v137
    v_lshl_add_u32 v136, v136, 4, s21
    s_not_b32 s78, s36
    s_waitcnt vmcnt(9)
    v_lshlrev_b32 v80, 16, v36
    v_and_b32 v81, s36, v36
    v_lshlrev_b32 v82, 16, v37
    v_and_b32 v83, s36, v37
    v_lshlrev_b32 v84, 16, v38
    v_and_b32 v85, s36, v38
    v_lshlrev_b32 v86, 16, v39
    v_and_b32_e64 v87, s36, v39
    v_pk_mul_f32 v[80:81], v[80:81], s[38:39] op_sel_hi:[1,0]
    v_pk_mul_f32 v[82:83], v[82:83], s[38:39] op_sel_hi:[1,0]
    v_pk_mul_f32 v[84:85], v[84:85], s[38:39] op_sel_hi:[1,0]
    v_pk_mul_f32 v[86:87], v[86:87], s[38:39] op_sel_hi:[1,0]
    v_cvt_pk_bf16_f32 v36, v80, v81
    v_cvt_pk_bf16_f32 v37, v82, v83
    v_cvt_pk_bf16_f32 v38, v84, v85
    v_cvt_pk_bf16_f32 v39, v86, v87
    ds_write_b128 v128, v[36:39] offset:8320
    s_waitcnt vmcnt(8)
    v_lshlrev_b32 v72, 16, v32
    v_and_b32 v73, s36, v32
    v_lshlrev_b32 v74, 16, v33
    v_and_b32 v75, s36, v33
    v_lshlrev_b32 v76, 16, v34
    v_and_b32 v77, s36, v34
    v_lshlrev_b32 v78, 16, v35
    v_and_b32_e64 v79, s36, v35
    v_pk_mul_f32 v[72:73], v[72:73], s[38:39] op_sel_hi:[1,0]
    v_pk_mul_f32 v[74:75], v[74:75], s[38:39] op_sel_hi:[1,0]
    v_pk_mul_f32 v[76:77], v[76:77], s[38:39] op_sel_hi:[1,0]
    v_pk_mul_f32 v[78:79], v[78:79], s[38:39] op_sel_hi:[1,0]
    s_waitcnt vmcnt(7)
    v_lshlrev_b32 v64, 16, v28
    v_and_b32 v65, s36, v28
    v_lshlrev_b32 v66, 16, v29
    v_and_b32 v67, s36, v29
    v_lshlrev_b32 v68, 16, v30
    v_and_b32 v69, s36, v30
    v_lshlrev_b32 v70, 16, v31
    v_and_b32_e64 v71, s36, v31
    v_pk_fma_f32 v[64:65], v[64:65], s[38:39], v[72:73] op_sel_hi:[1,0,1] neg_lo:[0,0,1] neg_hi:[0,0,1]
    v_pk_fma_f32 v[66:67], v[66:67], s[38:39], v[74:75] op_sel_hi:[1,0,1] neg_lo:[0,0,1] neg_hi:[0,0,1]
    v_pk_fma_f32 v[68:69], v[68:69], s[38:39], v[76:77] op_sel_hi:[1,0,1] neg_lo:[0,0,1] neg_hi:[0,0,1]
    v_pk_fma_f32 v[70:71], v[70:71], s[38:39], v[78:79] op_sel_hi:[1,0,1] neg_lo:[0,0,1] neg_hi:[0,0,1]
    v_cvt_pk_bf16_f32 v28, v64, v65
    v_cvt_pk_bf16_f32 v29, v66, v67
    v_cvt_pk_bf16_f32 v30, v68, v69
    v_cvt_pk_bf16_f32 v31, v70, v71
    ds_write_b128 v128, v[28:31] offset:16640
    s_waitcnt vmcnt(6)
    v_lshlrev_b32 v56, 16, v24
    v_and_b32 v57, s36, v24
    v_lshlrev_b32 v58, 16, v25
    v_and_b32 v59, s36, v25
    v_lshlrev_b32 v60, 16, v26
    v_and_b32 v61, s36, v26
    v_lshlrev_b32 v62, 16, v27
    v_and_b32_e64 v63, s36, v27
    v_pk_fma_f32 v[56:57], v[56:57], s[38:39], v[72:73] op_sel_hi:[1,0,1]
    v_pk_fma_f32 v[58:59], v[58:59], s[38:39], v[74:75] op_sel_hi:[1,0,1]
    v_pk_fma_f32 v[60:61], v[60:61], s[38:39], v[76:77] op_sel_hi:[1,0,1]
    v_pk_fma_f32 v[62:63], v[62:63], s[38:39], v[78:79] op_sel_hi:[1,0,1]
    v_cvt_pk_bf16_f32 v24, v56, v57
    v_cvt_pk_bf16_f32 v25, v58, v59
    v_cvt_pk_bf16_f32 v26, v60, v61
    v_cvt_pk_bf16_f32 v27, v62, v63
    ds_write_b128 v128, v[24:27] offset:0
    s_waitcnt vmcnt(3)
    v_lshlrev_b32 v112, 16, v52
    v_and_b32 v113, s36, v52
    v_lshlrev_b32 v114, 16, v53
    v_and_b32 v115, s36, v53
    v_lshlrev_b32 v116, 16, v54
    v_and_b32 v117, s36, v54
    v_lshlrev_b32 v118, 16, v55
    v_and_b32_e64 v119, s36, v55
    v_pk_mul_f32 v[112:113], v[112:113], s[38:39] op_sel_hi:[1,0]
    v_pk_mul_f32 v[114:115], v[114:115], s[38:39] op_sel_hi:[1,0]
    v_pk_mul_f32 v[116:117], v[116:117], s[38:39] op_sel_hi:[1,0]
    v_pk_mul_f32 v[118:119], v[118:119], s[38:39] op_sel_hi:[1,0]
    v_cvt_pk_bf16_f32 v52, v112, v113
    v_cvt_pk_bf16_f32 v53, v114, v115
    v_cvt_pk_bf16_f32 v54, v116, v117
    v_cvt_pk_bf16_f32 v55, v118, v119
    ds_write_b128 v129, v[52:55] offset:8320
    s_waitcnt vmcnt(2)
    v_lshlrev_b32 v104, 16, v48
    v_and_b32 v105, s36, v48
    v_lshlrev_b32 v106, 16, v49
    v_and_b32 v107, s36, v49
    v_lshlrev_b32 v108, 16, v50
    v_and_b32 v109, s36, v50
    v_lshlrev_b32 v110, 16, v51
    v_and_b32_e64 v111, s36, v51
    v_pk_mul_f32 v[104:105], v[104:105], s[38:39] op_sel_hi:[1,0]
    v_pk_mul_f32 v[106:107], v[106:107], s[38:39] op_sel_hi:[1,0]
    v_pk_mul_f32 v[108:109], v[108:109], s[38:39] op_sel_hi:[1,0]
    v_pk_mul_f32 v[110:111], v[110:111], s[38:39] op_sel_hi:[1,0]
    s_waitcnt vmcnt(1)
    v_lshlrev_b32 v96, 16, v44
    v_and_b32 v97, s36, v44
    v_lshlrev_b32 v98, 16, v45
    v_and_b32 v99, s36, v45
    v_lshlrev_b32 v100, 16, v46
    v_and_b32 v101, s36, v46
    v_lshlrev_b32 v102, 16, v47
    v_and_b32_e64 v103, s36, v47
    v_pk_fma_f32 v[96:97], v[96:97], s[38:39], v[104:105] op_sel_hi:[1,0,1] neg_lo:[0,0,1] neg_hi:[0,0,1]
    v_pk_fma_f32 v[98:99], v[98:99], s[38:39], v[106:107] op_sel_hi:[1,0,1] neg_lo:[0,0,1] neg_hi:[0,0,1]
    v_pk_fma_f32 v[100:101], v[100:101], s[38:39], v[108:109] op_sel_hi:[1,0,1] neg_lo:[0,0,1] neg_hi:[0,0,1]
    v_pk_fma_f32 v[102:103], v[102:103], s[38:39], v[110:111] op_sel_hi:[1,0,1] neg_lo:[0,0,1] neg_hi:[0,0,1]
    v_cvt_pk_bf16_f32 v44, v96, v97
    v_cvt_pk_bf16_f32 v45, v98, v99
    v_cvt_pk_bf16_f32 v46, v100, v101
    v_cvt_pk_bf16_f32 v47, v102, v103
    ds_write_b128 v129, v[44:47] offset:16640
    s_waitcnt vmcnt(0)
    v_lshlrev_b32 v88, 16, v40
    v_and_b32 v89, s36, v40
    v_lshlrev_b32 v90, 16, v41
    v_and_b32 v91, s36, v41
    v_lshlrev_b32 v92, 16, v42
    v_and_b32 v93, s36, v42
    v_lshlrev_b32 v94, 16, v43
    v_and_b32_e64 v95, s36, v43
    v_pk_fma_f32 v[88:89], v[88:89], s[38:39], v[104:105] op_sel_hi:[1,0,1]
    v_pk_fma_f32 v[90:91], v[90:91], s[38:39], v[106:107] op_sel_hi:[1,0,1]
    v_pk_fma_f32 v[92:93], v[92:93], s[38:39], v[108:109] op_sel_hi:[1,0,1]
    v_pk_fma_f32 v[94:95], v[94:95], s[38:39], v[110:111] op_sel_hi:[1,0,1]
    v_cvt_pk_bf16_f32 v40, v88, v89
    v_cvt_pk_bf16_f32 v41, v90, v91
    v_cvt_pk_bf16_f32 v42, v92, v93
    v_cvt_pk_bf16_f32 v43, v94, v95
    ds_write_b128 v129, v[40:43] offset:0
    s_waitcnt lgkmcnt(0)
    s_barrier
    s_setprio 0
    ds_read_b128 v[24:27], v136 offset:2048
    ds_read_b128 v[28:31], v136 offset:3104
    s_waitcnt lgkmcnt(0)
    v_and_b32 v56, s78, v24
    v_and_b32 v57, s78, v25
    v_and_b32 v58, s78, v26
    v_and_b32 v59, s78, v27
    v_and_b32 v60, s36, v24
    v_and_b32 v61, s36, v25
    v_and_b32 v62, s36, v26
    v_and_b32 v63, s36, v27
    v_and_b32 v64, s78, v28
    v_and_b32 v65, s78, v29
    v_and_b32 v66, s78, v30
    v_and_b32 v67, s78, v31
    v_and_b32 v68, s36, v28
    v_and_b32 v69, s36, v29
    v_and_b32 v70, s36, v30
    v_and_b32_e64 v71, s36, v31
    s_barrier
    ds_write_b128 v137, v[56:59] offset:4224
    ds_write_b128 v137, v[60:63] offset:4352
    ds_write_b128 v137, v[64:67] offset:6400
    ds_write_b128 v137, v[68:71] offset:6528
    s_waitcnt lgkmcnt(0)
    s_barrier
    s_endpgm
L_fused:
    s_barrier
    ds_read_u16 v158, v21 offset:25600
    ds_read_u16 v159, v21 offset:25664
    ds_read_u16 v2, v18 offset:25856
    ds_read_b64_tr_b16 a[64:65], v20 offset:16640
    ds_read_b64_tr_b16 a[66:67], v20 offset:16896
    ds_read_b64_tr_b16 a[68:69], v20 offset:17664
    ds_read_b64_tr_b16 a[70:71], v20 offset:17920
    ds_read_b64_tr_b16 a[72:73], v20 offset:18688
    ds_read_b64_tr_b16 a[74:75], v20 offset:18944
    ds_read_b64_tr_b16 a[76:77], v20 offset:19712
    ds_read_b64_tr_b16 a[78:79], v20 offset:19968
    ds_read_b64_tr_b16 a[0:1], v20 offset:0
    ds_read_b64_tr_b16 a[2:3], v20 offset:256
    ds_read_b64_tr_b16 a[4:5], v20 offset:1024
    ds_read_b64_tr_b16 a[6:7], v20 offset:1280
    s_waitcnt lgkmcnt(12)
    v_lshlrev_b32 v158, 16, v158
    v_lshlrev_b32 v159, 16, v159
    v_lshlrev_b32 v2, 16, v2
    v_pk_mul_f32 v[120:121], v[158:159], s[38:39] op_sel:[0,0] op_sel_hi:[0,0]
    v_pk_mul_f32 v[122:123], v[158:159], s[38:39] op_sel:[0,0] op_sel_hi:[0,0]
    v_pk_mul_f32 v[124:125], v[158:159], s[38:39] op_sel:[0,0] op_sel_hi:[0,0]
    v_pk_mul_f32 v[126:127], v[158:159], s[38:39] op_sel:[0,0] op_sel_hi:[0,0]
    s_waitcnt lgkmcnt(4)
    s_nop 0
    v_mfma_f32_32x32x16_bf16 v[120:135], a[16:19], a[64:67], v[120:135]
    ds_read_b64_tr_b16 a[8:9], v20 offset:2048
    ds_read_b64_tr_b16 a[10:11], v20 offset:2304
    ds_read_b64_tr_b16 a[12:13], v20 offset:3072
    ds_read_b64_tr_b16 a[14:15], v20 offset:3328
    v_mfma_f32_32x32x16_bf16 v[120:135], a[20:23], a[68:71], v[120:135]
    s_waitcnt vmcnt(4)
    ds_read_b128 v[24:27], v4 offset:4224
    ds_read_b128 v[28:31], v4 offset:4256
    ds_read_b128 v[32:35], v4 offset:4288
    ds_read_b128 v[36:39], v4 offset:4320
    v_mfma_f32_32x32x16_bf16 v[120:135], a[24:27], a[72:75], v[120:135]
    s_nop 0
    ds_read_b64_tr_b16 a[48:49], v20 offset:20800
    ds_read_b64_tr_b16 a[50:51], v20 offset:21056
    ds_read_b64_tr_b16 a[52:53], v20 offset:21824
    ds_read_b64_tr_b16 a[54:55], v20 offset:22080
    v_mfma_f32_32x32x16_bf16 v[120:135], a[28:31], a[76:79], v[120:135]
    s_add_u32 m0, s34, 0
    ds_read_b64_tr_b16 a[56:57], v20 offset:22848
    ds_read_b64_tr_b16 a[58:59], v20 offset:23104
    ds_read_b64_tr_b16 a[60:61], v20 offset:23872
    ds_read_b64_tr_b16 a[62:63], v20 offset:24128
    s_waitcnt lgkmcnt(8)
    v_lshlrev_b32 v40, 16, v24
    v_and_b32 v41, s36, v24
    v_mfma_f32_32x32x16_bf16 v[104:119], a[0:3], v[24:27], 0
    ds_read_b64_tr_b16 a[32:33], v20 offset:8320
    ds_read_b64_tr_b16 a[34:35], v20 offset:8576
    v_lshlrev_b32 v42, 16, v25
    v_and_b32 v43, s36, v25
    v_lshlrev_b32 v44, 16, v26
    v_and_b32 v45, s36, v26
    v_mfma_f32_32x32x16_bf16 v[104:119], a[4:7], v[28:31], v[104:119]
    ds_read_b64_tr_b16 a[36:37], v20 offset:9344
    ds_read_b64_tr_b16 a[38:39], v20 offset:9600
    v_lshlrev_b32 v46, 16, v27
    v_and_b32 v47, s36, v27
    v_lshlrev_b32 v48, 16, v28
    v_and_b32 v49, s36, v28
    v_mfma_f32_32x32x16_bf16 v[104:119], a[8:11], v[32:35], v[104:119]
    v_cvt_pk_bf16_f32 v152, v120, v121
    v_cvt_pk_bf16_f32 v153, v122, v123
    v_cvt_pk_bf16_f32 v154, v124, v125
    v_cvt_pk_bf16_f32 v155, v126, v127
    v_mul_f32 v120, s38, v159
    v_mul_f32 v121, s38, v159
    v_mfma_f32_32x32x16_bf16 v[104:119], a[12:15], v[36:39], v[104:119]
    v_mul_f32 v122, s38, v159
    v_mul_f32 v123, s38, v159
    v_mul_f32 v124, s38, v159
    v_mul_f32 v125, s38, v159
    v_mul_f32 v126, s38, v159
    v_mul_f32 v127, s38, v159
    v_mfma_f32_32x32x16_bf16 v[104:119], v[152:155], a[80:83], v[104:119]
    s_waitcnt lgkmcnt(4)
    ds_read_b64_tr_b16 a[40:41], v20 offset:10368
    ds_read_b64_tr_b16 a[42:43], v20 offset:10624
    v_lshlrev_b32 v50, 16, v29
    v_and_b32 v51, s36, v29
    v_lshlrev_b32 v52, 16, v30
    v_and_b32_e64 v53, s36, v30
    v_mfma_f32_32x32x16_bf16 v[120:135], a[16:19], a[48:51], v[120:135]
    ds_read_b64_tr_b16 a[44:45], v20 offset:11392
    ds_read_b64_tr_b16 a[46:47], v20 offset:11648
    v_lshlrev_b32 v54, 16, v31
    v_and_b32 v55, s36, v31
    v_lshlrev_b32 v56, 16, v32
    v_and_b32 v57, s36, v32
    v_mfma_f32_32x32x16_bf16 v[120:135], a[20:23], a[52:55], v[120:135]
    ds_read_b32 v13, v6 offset:640
    ds_read_b128 v[164:167], v7 offset:768
    v_lshlrev_b32 v58, 16, v33
    v_and_b32 v59, s36, v33
    v_lshlrev_b32 v60, 16, v34
    v_and_b32 v61, s36, v34
    v_mfma_f32_32x32x16_bf16 v[120:135], a[24:27], a[56:59], v[120:135]
    v_lshlrev_b32 v62, 16, v35
    v_and_b32 v63, s36, v35
    v_lshlrev_b32 v64, 16, v36
    v_and_b32 v65, s36, v36
    v_lshlrev_b32 v66, 16, v37
    v_and_b32_e64 v67, s36, v37
    v_mfma_f32_32x32x16_bf16 v[120:135], a[28:31], a[60:63], v[120:135]
    s_waitcnt lgkmcnt(0)
    ds_read_b64_tr_b16 a[16:17], v20 offset:4160
    ds_read_b64_tr_b16 a[18:19], v20 offset:4416
    ds_read_b64_tr_b16 a[20:21], v20 offset:5184
    ds_read_b64_tr_b16 a[22:23], v20 offset:5440
    ds_read_b64_tr_b16 a[24:25], v20 offset:6208
    v_lshlrev_b32 v68, 16, v38
    v_and_b32 v69, s36, v38
    v_lshlrev_b32 v70, 16, v39
    v_and_b32 v71, s36, v39
    v_pk_mul_f32 v[40:41], v[40:41], v[72:73]
    v_pk_mul_f32 v[42:43], v[42:43], v[74:75]
    v_pk_mul_f32 v[44:45], v[44:45], v[76:77]
    v_pk_mul_f32 v[46:47], v[46:47], v[78:79]
    v_pk_mul_f32 v[48:49], v[48:49], v[80:81]
    v_pk_mul_f32 v[50:51], v[50:51], v[82:83]
    v_pk_mul_f32 v[52:53], v[52:53], v[84:85]
    v_pk_mul_f32 v[54:55], v[54:55], v[86:87]
    v_cvt_pk_bf16_f32 v40, v40, v41
    v_cvt_pk_bf16_f32 v41, v42, v43
    v_cvt_pk_bf16_f32 v42, v44, v45
    v_cvt_pk_bf16_f32 v43, v46, v47
    v_pk_mul_f32 v[56:57], v[56:57], v[88:89]
    v_pk_mul_f32 v[58:59], v[58:59], v[90:91]
    v_pk_mul_f32 v[60:61], v[60:61], v[92:93]
    v_pk_mul_f32 v[62:63], v[62:63], v[94:95]
    v_cvt_pk_bf16_f32 v156, v120, v121
    v_cvt_pk_bf16_f32 v157, v122, v123
    v_cvt_pk_bf16_f32 v158, v124, v125
    v_cvt_pk_bf16_f32 v159, v126, v127
    v_pk_mul_f32 v[64:65], v[64:65], v[96:97]
    v_pk_mul_f32 v[66:67], v[66:67], v[98:99]
    v_pk_mul_f32 v[68:69], v[68:69], v[100:101]
    v_pk_mul_f32 v[70:71], v[70:71], v[102:103]
    v_mfma_f32_32x32x16_bf16 v[104:119], a[32:35], v[40:43], v[104:119]
    ds_read_b64_tr_b16 a[26:27], v20 offset:6464
    ds_read_b64_tr_b16 a[28:29], v20 offset:7232
    ds_read_b64_tr_b16 a[30:31], v20 offset:7488
    v_cvt_pk_bf16_f32 v48, v48, v49
    v_cvt_pk_bf16_f32 v49, v50, v51
    v_cvt_pk_bf16_f32 v50, v52, v53
    v_cvt_pk_bf16_f32 v51, v54, v55
    v_cvt_pk_bf16_f32 v56, v56, v57
    v_cvt_pk_bf16_f32 v57, v58, v59
    v_mfma_f32_32x32x16_bf16 v[104:119], a[36:39], v[48:51], v[104:119]
    v_cvt_pk_bf16_f32 v58, v60, v61
    v_cvt_pk_bf16_f32 v59, v62, v63
    v_cvt_pk_bf16_f32 v64, v64, v65
    v_cvt_pk_bf16_f32 v65, v66, v67
    v_cvt_pk_bf16_f32 v66, v68, v69
    v_cvt_pk_bf16_f32 v67, v70, v71
    v_mfma_f32_32x32x16_bf16 v[104:119], a[40:43], v[56:59], v[104:119]
    v_and_b32_e64 v15, s79, v13
    v_lshl_add_u32 v16, v15, 2, v8
    v_mad_u32_u24 v23, v15, s37, v11
    v_and_or_b32 v164, v164, s22, v3
    v_and_or_b32 v165, v165, s22, v3
    v_and_or_b32 v166, v166, s22, v3
    v_and_or_b32 v167, v167, s22, v3
    v_mfma_f32_32x32x16_bf16 v[104:119], a[44:47], v[64:67], v[104:119]
    ds_read_b64_tr_b16 a[48:49], v20 offset:12480
    ds_read_b64_tr_b16 a[50:51], v20 offset:12736
    ds_read_b64_tr_b16 a[52:53], v20 offset:13504
    ds_read_b64_tr_b16 a[54:55], v20 offset:13760
    ds_read_b64_tr_b16 a[56:57], v20 offset:14528
    ds_read_b64_tr_b16 a[58:59], v20 offset:14784
    v_mfma_f32_32x32x16_bf16 v[120:135], v[156:159], a[80:83], 0
    s_waitcnt lgkmcnt(6)
    ds_read_b64_tr_b16 a[60:61], v20 offset:15552
    ds_read_b64_tr_b16 a[62:63], v20 offset:15808
    v_lshl_add_u32 v17, v14, 2, v9
    v_and_b32 v18, s36, v12
    v_exp_f32_e64 v104, v104
    v_mfma_f32_32x32x16_bf16 v[120:135], a[16:19], v[24:27], v[120:135]
    ds_read_b128 a[64:67], v22 offset:0
    ds_read_b128 a[68:71], v22 offset:16
    v_exp_f32 v105, v105
    v_exp_f32 v106, v106
    v_mfma_f32_32x32x16_bf16 v[120:135], a[20:23], v[28:31], v[120:135]
    ds_read_b128 a[72:75], v22 offset:64
    ds_read_b128 a[76:79], v22 offset:80
    v_exp_f32 v107, v107
    v_exp_f32 v108, v108
    v_mfma_f32_32x32x16_bf16 v[120:135], a[24:27], v[32:35], v[120:135]
    ds_read_b128 a[80:83], v16
    v_exp_f32 v109, v109
    v_exp_f32 v110, v110
    v_exp_f32 v111, v111
    v_mfma_f32_32x32x16_bf16 v[120:135], a[28:31], v[36:39], v[120:135]
    v_exp_f32 v112, v112
    v_exp_f32 v113, v113
    v_exp_f32 v114, v114
    v_exp_f32 v115, v115
    v_exp_f32 v116, v116
    v_exp_f32 v117, v117
    v_exp_f32 v118, v118
    v_exp_f32_e64 v119, v119
    v_pk_add_f32 v[104:105], v[104:105], 1.0 op_sel_hi:[1,0]
    v_pk_add_f32 v[106:107], v[106:107], 1.0 op_sel_hi:[1,0]
    v_pk_add_f32 v[108:109], v[108:109], 1.0 op_sel_hi:[1,0]
    v_pk_add_f32 v[110:111], v[110:111], 1.0 op_sel_hi:[1,0]
    v_pk_add_f32 v[112:113], v[112:113], 1.0 op_sel_hi:[1,0]
    v_pk_add_f32 v[114:115], v[114:115], 1.0 op_sel_hi:[1,0]
    v_pk_add_f32 v[116:117], v[116:117], 1.0 op_sel_hi:[1,0]
    v_pk_add_f32 v[118:119], v[118:119], 1.0 op_sel_hi:[1,0]
    s_waitcnt lgkmcnt(0)
    v_mfma_f32_32x32x16_bf16 v[120:135], a[48:51], v[40:43], v[120:135]
    v_rcp_f32 v104, v104
    v_rcp_f32 v105, v105
    v_rcp_f32 v106, v106
    v_mfma_f32_32x32x16_bf16 v[120:135], a[52:55], v[48:51], v[120:135]
    v_rcp_f32 v107, v107
    v_rcp_f32 v108, v108
    v_rcp_f32 v109, v109
    v_mfma_f32_32x32x16_bf16 v[120:135], a[56:59], v[56:59], v[120:135]
    v_rcp_f32 v110, v110
    v_rcp_f32 v111, v111
    v_rcp_f32 v112, v112
    v_mfma_f32_32x32x16_bf16 v[120:135], a[60:63], v[64:67], v[120:135]
    s_barrier
    v_rcp_f32 v113, v113
    v_rcp_f32 v114, v114
    v_rcp_f32 v115, v115
    v_rcp_f32 v116, v116
    v_rcp_f32 v117, v117
    v_rcp_f32 v118, v118
    v_rcp_f32 v119, v119
    v_cvt_pk_bf16_f32 v44, v104, v105
    v_cvt_pk_bf16_f32 v45, v106, v107
    v_cvt_pk_bf16_f32 v46, v108, v109
    v_cvt_pk_bf16_f32 v47, v110, v111
    v_cvt_pk_bf16_f32 v52, v112, v113
    v_cvt_pk_bf16_f32 v53, v114, v115
    v_cvt_pk_bf16_f32 v54, v116, v117
    v_cvt_pk_bf16_f32 v55, v118, v119
    v_exp_f32 v120, v120
    v_exp_f32 v121, v121
    v_exp_f32 v122, v122
    v_exp_f32 v123, v123
    v_exp_f32 v124, v124
    v_exp_f32 v125, v125
    v_exp_f32 v126, v126
    v_exp_f32 v127, v127
    v_exp_f32 v128, v128
    v_exp_f32 v129, v129
    v_exp_f32 v130, v130
    v_exp_f32 v131, v131
    v_exp_f32 v132, v132
    v_exp_f32 v133, v133
    v_exp_f32 v134, v134
    v_exp_f32 v135, v135
    v_pk_add_f32 v[120:121], v[120:121], 1.0 op_sel_hi:[1,0]
    v_pk_add_f32 v[122:123], v[122:123], 1.0 op_sel_hi:[1,0]
    v_pk_add_f32 v[124:125], v[124:125], 1.0 op_sel_hi:[1,0]
    v_pk_add_f32 v[126:127], v[126:127], 1.0 op_sel_hi:[1,0]
    v_pk_add_f32 v[128:129], v[128:129], 1.0 op_sel_hi:[1,0]
    v_pk_add_f32 v[130:131], v[130:131], 1.0 op_sel_hi:[1,0]
    v_pk_add_f32 v[132:133], v[132:133], 1.0 op_sel_hi:[1,0]
    v_pk_add_f32 v[134:135], v[134:135], 1.0 op_sel_hi:[1,0]
    v_rcp_f32 v120, v120
    v_rcp_f32 v121, v121
    v_rcp_f32 v122, v122
    v_rcp_f32 v123, v123
    v_rcp_f32 v124, v124
    v_rcp_f32 v125, v125
    v_rcp_f32_e64 v126, v126
    v_cvt_pk_bf16_f32 v60, v120, v121
    v_cvt_pk_bf16_f32 v61, v122, v123
    v_cvt_pk_bf16_f32 v62, v124, v125
    v_rcp_f32 v127, v127
    v_rcp_f32 v128, v128
    s_barrier
    v_mfma_f32_32x32x16_bf16 v[104:119], v[152:155], a[80:83], 0
    s_waitcnt vmcnt(0)
    ds_read_b128 v[24:27], v4 offset:8448
    ds_read_b128 v[28:31], v4 offset:8480
    ds_read_b128 v[32:35], v4 offset:8512
    ds_read_b128 v[36:39], v4 offset:8544
    v_rcp_f32_e64 v129, v129
    v_cvt_pk_bf16_f32 v63, v126, v127
    v_mfma_f32_16x16x32_bf16 v[160:163], a[64:67], v[44:47], v[2:5]
    buffer_load_dwordx4 v164, s[24:27], 0 offen offset:0 nt lds
    buffer_load_dwordx4 v165, s[28:31], 0 offen offset:1056 nt lds
    buffer_load_dwordx4 v166, s[40:43], 0 offen offset:2112 nt lds
    buffer_load_dwordx4 v167, s[44:47], 0 offen offset:3168 nt lds
    v_mfma_f32_16x16x32_bf16 v[160:163], a[68:71], v[52:55], v[160:163]
    v_rcp_f32 v130, v130
    v_mfma_f32_16x16x32_bf16 v[160:163], a[72:75], v[60:63], v[160:163]
    s_waitcnt lgkmcnt(2)
    v_rcp_f32_e64 v131, v131
    v_mfma_f32_32x32x16_bf16 v[104:119], a[0:3], v[24:27], v[104:119]
    ds_read_b32 v12, v6 offset:768
    ds_read_b128 v[168:171], v7 offset:896
    ds_read_b128 v[72:75], v23 offset:4224
    ds_read_b128 v[76:79], v23 offset:4352
    v_rcp_f32 v132, v132
    v_mfma_f32_32x32x16_bf16 v[104:119], a[4:7], v[28:31], v[104:119]
    s_waitcnt lgkmcnt(4)
    ds_read_b128 v[80:83], v23 offset:4256
    ds_read_b128 v[84:87], v23 offset:4384
    ds_read_b128 v[88:91], v23 offset:4288
    ds_read_b128 v[92:95], v23 offset:4416
    v_rcp_f32_e64 v133, v133
    v_mfma_f32_32x32x16_bf16 v[104:119], a[8:11], v[32:35], v[104:119]
    ds_read_b128 v[96:99], v23 offset:4320
    ds_read_b128 v[100:103], v23 offset:4448
    v_rcp_f32 v134, v134
    v_rcp_f32_e64 v135, v135
    v_mfma_f32_32x32x16_bf16 v[104:119], a[12:15], v[36:39], v[104:119]
    s_waitcnt lgkmcnt(6)
    v_cvt_pk_bf16_f32 v68, v128, v129
    v_cvt_pk_bf16_f32 v69, v130, v131
    v_cvt_pk_bf16_f32 v70, v132, v133
    v_cvt_pk_bf16_f32 v71, v134, v135
    v_and_b32 v14, s79, v12
    v_lshl_add_u32 v16, v14, 2, v8
    v_mfma_f32_16x16x32_bf16 v[160:163], a[76:79], v[68:71], v[160:163]
    s_waitcnt lgkmcnt(0)
    v_mad_u32_u24 v23, v14, s37, v11
    v_and_or_b32 v168, v168, s22, v3
    v_and_or_b32 v169, v169, s22, v3
    v_and_or_b32 v170, v170, s22, v3
    v_and_or_b32 v171, v171, s22, v3
L_p5:
    v_dot2_f32_bf16 v40, v24, v72, 0
    v_dot2_f32_bf16 v41, v24, v76, 0
    v_dot2_f32_bf16 v42, v25, v73, 0
    v_dot2_f32_bf16 v43, v25, v77, 0
    v_dot2_f32_bf16 v44, v26, v74, 0
    v_dot2_f32_bf16 v45, v26, v78, 0
    v_dot2_f32_bf16 v46, v27, v75, 0
    v_dot2_f32_bf16 v47, v27, v79, 0
    v_mul_f32_e64 v19, v160, v18
    v_dot2_f32_bf16 v48, v28, v80, 0
    v_dot2_f32_bf16 v49, v28, v84, 0
    v_dot2_f32_bf16 v50, v29, v81, 0
    v_dot2_f32_bf16 v51, v29, v85, 0
    v_cvt_pk_bf16_f32 v19, v19, v19
    v_dot2_f32_bf16 v52, v30, v82, 0
    v_dot2_f32_bf16 v53, v30, v86, 0
    v_dot2_f32_bf16 v54, v31, v83, 0
    v_dot2_f32_bf16 v55, v31, v87, 0
    v_dot2_f32_bf16 v56, v32, v88, 0
    v_dot2_f32_bf16 v57, v32, v92, 0
    v_dot2_f32_bf16 v58, v33, v89, 0
    v_dot2_f32_bf16 v59, v33, v93, 0
    v_cvt_pk_bf16_f32 v40, v40, v41
    v_cvt_pk_bf16_f32 v41, v42, v43
    v_cvt_pk_bf16_f32 v42, v44, v45
    v_cvt_pk_bf16_f32 v43, v46, v47
    v_dot2_f32_bf16 v60, v34, v90, 0
    v_dot2_f32_bf16 v61, v34, v94, 0
    v_dot2_f32_bf16 v62, v35, v91, 0
    v_dot2_f32_bf16 v63, v35, v95, 0
    v_dot2_f32_bf16 v64, v36, v96, 0
    v_dot2_f32_bf16 v65, v36, v100, 0
    v_dot2_f32_bf16 v66, v37, v97, 0
    v_dot2_f32_bf16 v67, v37, v101, 0
    v_dot2_f32_bf16 v68, v38, v98, 0
    v_dot2_f32_bf16 v69, v38, v102, 0
    v_dot2_f32_bf16 v70, v39, v99, 0
    v_dot2_f32_bf16 v71, v39, v103, 0
    v_mfma_f32_32x32x16_bf16 v[104:119], a[32:35], v[40:43], v[104:119]
    v_cvt_pk_bf16_f32 v48, v48, v49
    v_cvt_pk_bf16_f32 v49, v50, v51
    v_cvt_pk_bf16_f32 v50, v52, v53
    v_cvt_pk_bf16_f32 v51, v54, v55
    v_cvt_pk_bf16_f32 v56, v56, v57
    v_cvt_pk_bf16_f32 v57, v58, v59
    v_mfma_f32_32x32x16_bf16 v[104:119], a[36:39], v[48:51], v[104:119]
    v_cvt_pk_bf16_f32 v58, v60, v61
    v_cvt_pk_bf16_f32 v59, v62, v63
    v_cvt_pk_bf16_f32 v64, v64, v65
    v_cvt_pk_bf16_f32 v65, v66, v67
    v_cvt_pk_bf16_f32 v66, v68, v69
    v_cvt_pk_bf16_f32 v67, v70, v71
    v_mfma_f32_32x32x16_bf16 v[104:119], a[40:43], v[56:59], v[104:119]
    ds_read_b64_tr_b16 v[72:73], v5 offset:4224
    ds_read_b64_tr_b16 v[74:75], v5 offset:4736
    ds_write_b16 v17, v19 offset:14288
    v_lshl_add_u32 v17, v15, 2, v9
    v_and_b32 v18, s36, v13
    v_mfma_f32_32x32x16_bf16 v[104:119], a[44:47], v[64:67], v[104:119]
    s_nop 0
    ds_read_b64_tr_b16 v[76:77], v5 offset:4256
    ds_read_b64_tr_b16 v[78:79], v5 offset:4768
    ds_read_b64_tr_b16 v[80:81], v5 offset:4288
    ds_read_b64_tr_b16 v[82:83], v5 offset:4800
    ds_read_b64_tr_b16 v[84:85], v5 offset:4320
    ds_read_b64_tr_b16 v[86:87], v5 offset:4832
    v_mfma_f32_32x32x16_bf16 v[120:135], v[156:159], a[80:83], 0
    ds_read_b128 v[88:91], v10 offset:14288
    ds_read_b32 v13, v6 offset:896
    ds_read_b128 v[164:167], v7 offset:1024
    ds_read_b128 a[80:83], v16
    v_exp_f32 v104, v104
    v_mfma_f32_32x32x16_bf16 v[120:135], a[16:19], v[24:27], v[120:135]
    v_exp_f32 v105, v105
    v_exp_f32 v106, v106
    v_exp_f32 v107, v107
    v_mfma_f32_32x32x16_bf16 v[120:135], a[20:23], v[28:31], v[120:135]
    v_exp_f32 v108, v108
    v_exp_f32 v109, v109
    v_exp_f32 v110, v110
    v_mfma_f32_32x32x16_bf16 v[120:135], a[24:27], v[32:35], v[120:135]
    v_exp_f32 v111, v111
    v_exp_f32 v112, v112
    v_exp_f32 v113, v113
    v_mfma_f32_32x32x16_bf16 v[120:135], a[28:31], v[36:39], v[120:135]
    v_exp_f32 v114, v114
    v_exp_f32 v115, v115
    v_exp_f32 v116, v116
    v_exp_f32 v117, v117
    v_exp_f32 v118, v118
    v_exp_f32 v119, v119
    v_pk_add_f32 v[104:105], v[104:105], 1.0 op_sel_hi:[1,0]
    v_pk_add_f32 v[106:107], v[106:107], 1.0 op_sel_hi:[1,0]
    v_pk_add_f32 v[108:109], v[108:109], 1.0 op_sel_hi:[1,0]
    v_pk_add_f32 v[110:111], v[110:111], 1.0 op_sel_hi:[1,0]
    v_pk_add_f32 v[112:113], v[112:113], 1.0 op_sel_hi:[1,0]
    v_pk_add_f32 v[114:115], v[114:115], 1.0 op_sel_hi:[1,0]
    v_pk_add_f32 v[116:117], v[116:117], 1.0 op_sel_hi:[1,0]
    v_pk_add_f32 v[118:119], v[118:119], 1.0 op_sel_hi:[1,0]
    v_mfma_f32_32x32x16_bf16 v[120:135], a[48:51], v[40:43], v[120:135]
    s_waitcnt lgkmcnt(0)
    v_rcp_f32 v104, v104
    v_rcp_f32 v105, v105
    v_rcp_f32 v106, v106
    v_mfma_f32_32x32x16_bf16 v[120:135], a[52:55], v[48:51], v[120:135]
    s_add_u32 m0, s34, 4224
    v_rcp_f32 v107, v107
    v_rcp_f32 v108, v108
    v_rcp_f32 v109, v109
    v_mfma_f32_32x32x16_bf16 v[120:135], a[56:59], v[56:59], v[120:135]
    v_rcp_f32 v110, v110
    v_rcp_f32 v111, v111
    v_rcp_f32 v112, v112
    v_mfma_f32_32x32x16_bf16 v[120:135], a[60:63], v[64:67], v[120:135]
    v_rcp_f32 v113, v113
    v_rcp_f32 v114, v114
    v_rcp_f32 v115, v115
    v_mfma_f32_16x16x32_bf16 v[136:139], v[72:75], v[88:91], v[136:139]
    v_rcp_f32 v116, v116
    v_mfma_f32_16x16x32_bf16 v[140:143], v[76:79], v[88:91], v[140:143]
    v_rcp_f32 v117, v117
    v_mfma_f32_16x16x32_bf16 v[144:147], v[80:83], v[88:91], v[144:147]
    v_rcp_f32 v118, v118
    v_mfma_f32_16x16x32_bf16 v[148:151], v[84:87], v[88:91], v[148:151]
    ds_read_b128 v[72:75], v23 offset:4224
    ds_read_b128 v[76:79], v23 offset:4352
    ds_read_b128 v[80:83], v23 offset:4256
    ds_read_b128 v[84:87], v23 offset:4384
    ds_read_b128 v[88:91], v23 offset:4288
    ds_read_b128 v[92:95], v23 offset:4416
    ds_read_b128 v[96:99], v23 offset:4320
    ds_read_b128 v[100:103], v23 offset:4448
    v_rcp_f32_e64 v119, v119
    v_cvt_pk_bf16_f32 v44, v104, v105
    v_cvt_pk_bf16_f32 v45, v106, v107
    v_cvt_pk_bf16_f32 v46, v108, v109
    v_cvt_pk_bf16_f32 v47, v110, v111
    v_cvt_pk_bf16_f32 v52, v112, v113
    v_cvt_pk_bf16_f32 v53, v114, v115
    v_cvt_pk_bf16_f32 v54, v116, v117
    v_cvt_pk_bf16_f32 v55, v118, v119
    v_exp_f32 v120, v120
    v_exp_f32 v121, v121
    v_exp_f32 v122, v122
    v_exp_f32 v123, v123
    v_exp_f32 v124, v124
    v_exp_f32 v125, v125
    v_exp_f32 v126, v126
    v_exp_f32 v127, v127
    v_exp_f32 v128, v128
    v_exp_f32 v129, v129
    v_exp_f32 v130, v130
    v_exp_f32 v131, v131
    v_exp_f32 v132, v132
    v_exp_f32 v133, v133
    v_exp_f32 v134, v134
    v_exp_f32 v135, v135
    v_pk_add_f32 v[120:121], v[120:121], 1.0 op_sel_hi:[1,0]
    v_pk_add_f32 v[122:123], v[122:123], 1.0 op_sel_hi:[1,0]
    v_pk_add_f32 v[124:125], v[124:125], 1.0 op_sel_hi:[1,0]
    v_pk_add_f32 v[126:127], v[126:127], 1.0 op_sel_hi:[1,0]
    v_pk_add_f32 v[128:129], v[128:129], 1.0 op_sel_hi:[1,0]
    v_pk_add_f32 v[130:131], v[130:131], 1.0 op_sel_hi:[1,0]
    v_pk_add_f32 v[132:133], v[132:133], 1.0 op_sel_hi:[1,0]
    v_pk_add_f32 v[134:135], v[134:135], 1.0 op_sel_hi:[1,0]
    v_rcp_f32 v120, v120
    v_rcp_f32 v121, v121
    v_rcp_f32 v122, v122
    v_rcp_f32 v123, v123
    v_rcp_f32 v124, v124
    v_mfma_f32_32x32x16_bf16 v[104:119], v[152:155], a[80:83], 0
    s_waitcnt vmcnt(0)
    ds_read_b128 v[24:27], v4 offset:0
    ds_read_b128 v[28:31], v4 offset:32
    ds_read_b128 v[32:35], v4 offset:64
    ds_read_b128 v[36:39], v4 offset:96
    v_rcp_f32 v125, v125
    v_rcp_f32 v126, v126
    v_mfma_f32_16x16x32_bf16 v[160:163], a[64:67], v[44:47], v[2:5]
    buffer_load_dwordx4 v168, s[24:27], 0 offen offset:0 nt lds
    buffer_load_dwordx4 v169, s[28:31], 0 offen offset:1056 nt lds
    buffer_load_dwordx4 v170, s[40:43], 0 offen offset:2112 nt lds
    buffer_load_dwordx4 v171, s[44:47], 0 offen offset:3168 nt lds
    v_mfma_f32_16x16x32_bf16 v[160:163], a[68:71], v[52:55], v[160:163]
    s_waitcnt lgkmcnt(3)
    v_rcp_f32 v127, v127
    v_mfma_f32_32x32x16_bf16 v[104:119], a[0:3], v[24:27], v[104:119]
    s_waitcnt lgkmcnt(2)
    v_rcp_f32 v128, v128
    v_cvt_pk_bf16_f32 v60, v120, v121
    v_cvt_pk_bf16_f32 v61, v122, v123
    v_cvt_pk_bf16_f32 v62, v124, v125
    v_cvt_pk_bf16_f32 v63, v126, v127
    v_mfma_f32_32x32x16_bf16 v[104:119], a[4:7], v[28:31], v[104:119]
    s_waitcnt lgkmcnt(0)
    v_rcp_f32 v129, v129
    v_rcp_f32 v130, v130
    v_rcp_f32 v131, v131
    v_mfma_f32_16x16x32_bf16 v[160:163], a[72:75], v[60:63], v[160:163]
    v_rcp_f32 v132, v132
    v_mfma_f32_32x32x16_bf16 v[104:119], a[8:11], v[32:35], v[104:119]
    v_rcp_f32 v133, v133
    v_rcp_f32 v134, v134
    v_rcp_f32 v135, v135
    v_mfma_f32_32x32x16_bf16 v[104:119], a[12:15], v[36:39], v[104:119]
    v_cvt_pk_bf16_f32 v68, v128, v129
    v_cvt_pk_bf16_f32 v69, v130, v131
    v_cvt_pk_bf16_f32 v70, v132, v133
    v_cvt_pk_bf16_f32 v71, v134, v135
    v_and_b32_e64 v15, s79, v13
    v_lshl_add_u32 v16, v15, 2, v8
    v_mfma_f32_16x16x32_bf16 v[160:163], a[76:79], v[68:71], v[160:163]
    v_mad_u32_u24 v23, v15, s37, v11
    v_and_or_b32 v164, v164, s22, v3
    v_and_or_b32 v165, v165, s22, v3
    v_and_or_b32 v166, v166, s22, v3
    v_and_or_b32 v167, v167, s22, v3
L_p6:
    v_dot2_f32_bf16 v40, v24, v72, 0
    v_dot2_f32_bf16 v41, v24, v76, 0
    v_dot2_f32_bf16 v42, v25, v73, 0
    v_dot2_f32_bf16 v43, v25, v77, 0
    v_dot2_f32_bf16 v44, v26, v74, 0
    v_dot2_f32_bf16 v45, v26, v78, 0
    v_dot2_f32_bf16 v46, v27, v75, 0
    v_dot2_f32_bf16 v47, v27, v79, 0
    v_mul_f32_e64 v19, v160, v18
    v_dot2_f32_bf16 v48, v28, v80, 0
    v_dot2_f32_bf16 v49, v28, v84, 0
    v_dot2_f32_bf16 v50, v29, v81, 0
    v_dot2_f32_bf16 v51, v29, v85, 0
    v_cvt_pk_bf16_f32 v19, v19, v19
    v_dot2_f32_bf16 v52, v30, v82, 0
    v_dot2_f32_bf16 v53, v30, v86, 0
    v_dot2_f32_bf16 v54, v31, v83, 0
    v_dot2_f32_bf16 v55, v31, v87, 0
    v_dot2_f32_bf16 v56, v32, v88, 0
    v_dot2_f32_bf16 v57, v32, v92, 0
    v_dot2_f32_bf16 v58, v33, v89, 0
    v_dot2_f32_bf16 v59, v33, v93, 0
    v_cvt_pk_bf16_f32 v40, v40, v41
    v_cvt_pk_bf16_f32 v41, v42, v43
    v_cvt_pk_bf16_f32 v42, v44, v45
    v_cvt_pk_bf16_f32 v43, v46, v47
    v_dot2_f32_bf16 v60, v34, v90, 0
    v_dot2_f32_bf16 v61, v34, v94, 0
    v_dot2_f32_bf16 v62, v35, v91, 0
    v_dot2_f32_bf16 v63, v35, v95, 0
    v_dot2_f32_bf16 v64, v36, v96, 0
    v_dot2_f32_bf16 v65, v36, v100, 0
    v_dot2_f32_bf16 v66, v37, v97, 0
    v_dot2_f32_bf16 v67, v37, v101, 0
    v_dot2_f32_bf16 v68, v38, v98, 0
    v_dot2_f32_bf16 v69, v38, v102, 0
    v_dot2_f32_bf16 v70, v39, v99, 0
    v_dot2_f32_bf16 v71, v39, v103, 0
    v_mfma_f32_32x32x16_bf16 v[104:119], a[32:35], v[40:43], v[104:119]
    v_cvt_pk_bf16_f32 v48, v48, v49
    v_cvt_pk_bf16_f32 v49, v50, v51
    v_cvt_pk_bf16_f32 v50, v52, v53
    v_cvt_pk_bf16_f32 v51, v54, v55
    v_cvt_pk_bf16_f32 v56, v56, v57
    v_cvt_pk_bf16_f32 v57, v58, v59
    v_mfma_f32_32x32x16_bf16 v[104:119], a[36:39], v[48:51], v[104:119]
    v_cvt_pk_bf16_f32 v58, v60, v61
    v_cvt_pk_bf16_f32 v59, v62, v63
    v_cvt_pk_bf16_f32 v64, v64, v65
    v_cvt_pk_bf16_f32 v65, v66, v67
    v_cvt_pk_bf16_f32 v66, v68, v69
    v_cvt_pk_bf16_f32 v67, v70, v71
    v_mfma_f32_32x32x16_bf16 v[104:119], a[40:43], v[56:59], v[104:119]
    ds_read_b64_tr_b16 v[72:73], v5 offset:8448
    ds_read_b64_tr_b16 v[74:75], v5 offset:8960
    ds_write_b16 v17, v19 offset:15376
    v_lshl_add_u32 v17, v14, 2, v9
    v_and_b32 v18, s36, v12
    v_mfma_f32_32x32x16_bf16 v[104:119], a[44:47], v[64:67], v[104:119]
    s_nop 0
    ds_read_b64_tr_b16 v[76:77], v5 offset:8480
    ds_read_b64_tr_b16 v[78:79], v5 offset:8992
    ds_read_b64_tr_b16 v[80:81], v5 offset:8512
    ds_read_b64_tr_b16 v[82:83], v5 offset:9024
    ds_read_b64_tr_b16 v[84:85], v5 offset:8544
    ds_read_b64_tr_b16 v[86:87], v5 offset:9056
    v_mfma_f32_32x32x16_bf16 v[120:135], v[156:159], a[80:83], 0
    ds_read_b128 v[88:91], v10 offset:15376
    ds_read_b32 v12, v6 offset:1024
    ds_read_b128 v[168:171], v7 offset:1152
    ds_read_b128 a[80:83], v16
    v_exp_f32 v104, v104
    v_mfma_f32_32x32x16_bf16 v[120:135], a[16:19], v[24:27], v[120:135]
    v_exp_f32 v105, v105
    v_exp_f32 v106, v106
    v_exp_f32 v107, v107
    v_mfma_f32_32x32x16_bf16 v[120:135], a[20:23], v[28:31], v[120:135]
    v_exp_f32 v108, v108
    v_exp_f32 v109, v109
    v_exp_f32 v110, v110
    v_mfma_f32_32x32x16_bf16 v[120:135], a[24:27], v[32:35], v[120:135]
    v_exp_f32 v111, v111
    v_exp_f32 v112, v112
    v_exp_f32 v113, v113
    v_mfma_f32_32x32x16_bf16 v[120:135], a[28:31], v[36:39], v[120:135]
    v_exp_f32 v114, v114
    v_exp_f32 v115, v115
    v_exp_f32 v116, v116
    v_exp_f32 v117, v117
    v_exp_f32 v118, v118
    v_exp_f32 v119, v119
    v_pk_add_f32 v[104:105], v[104:105], 1.0 op_sel_hi:[1,0]
    v_pk_add_f32 v[106:107], v[106:107], 1.0 op_sel_hi:[1,0]
    v_pk_add_f32 v[108:109], v[108:109], 1.0 op_sel_hi:[1,0]
    v_pk_add_f32 v[110:111], v[110:111], 1.0 op_sel_hi:[1,0]
    v_pk_add_f32 v[112:113], v[112:113], 1.0 op_sel_hi:[1,0]
    v_pk_add_f32 v[114:115], v[114:115], 1.0 op_sel_hi:[1,0]
    v_pk_add_f32 v[116:117], v[116:117], 1.0 op_sel_hi:[1,0]
    v_pk_add_f32 v[118:119], v[118:119], 1.0 op_sel_hi:[1,0]
    v_mfma_f32_32x32x16_bf16 v[120:135], a[48:51], v[40:43], v[120:135]
    s_waitcnt lgkmcnt(0)
    v_rcp_f32 v104, v104
    v_rcp_f32 v105, v105
    v_rcp_f32 v106, v106
    v_mfma_f32_32x32x16_bf16 v[120:135], a[52:55], v[48:51], v[120:135]
    s_add_u32 m0, s34, 8448
    v_rcp_f32 v107, v107
    v_rcp_f32 v108, v108
    v_rcp_f32 v109, v109
    v_mfma_f32_32x32x16_bf16 v[120:135], a[56:59], v[56:59], v[120:135]
    v_rcp_f32 v110, v110
    v_rcp_f32 v111, v111
    v_rcp_f32 v112, v112
    v_mfma_f32_32x32x16_bf16 v[120:135], a[60:63], v[64:67], v[120:135]
    v_rcp_f32 v113, v113
    v_rcp_f32 v114, v114
    v_rcp_f32 v115, v115
    v_mfma_f32_16x16x32_bf16 v[136:139], v[72:75], v[88:91], v[136:139]
    v_rcp_f32 v116, v116
    v_mfma_f32_16x16x32_bf16 v[140:143], v[76:79], v[88:91], v[140:143]
    v_rcp_f32 v117, v117
    v_mfma_f32_16x16x32_bf16 v[144:147], v[80:83], v[88:91], v[144:147]
    v_rcp_f32 v118, v118
    v_mfma_f32_16x16x32_bf16 v[148:151], v[84:87], v[88:91], v[148:151]
    ds_read_b128 v[72:75], v23 offset:4224
    ds_read_b128 v[76:79], v23 offset:4352
    ds_read_b128 v[80:83], v23 offset:4256
    ds_read_b128 v[84:87], v23 offset:4384
    ds_read_b128 v[88:91], v23 offset:4288
    ds_read_b128 v[92:95], v23 offset:4416
    ds_read_b128 v[96:99], v23 offset:4320
    ds_read_b128 v[100:103], v23 offset:4448
    v_rcp_f32_e64 v119, v119
    v_cvt_pk_bf16_f32 v44, v104, v105
    v_cvt_pk_bf16_f32 v45, v106, v107
    v_cvt_pk_bf16_f32 v46, v108, v109
    v_cvt_pk_bf16_f32 v47, v110, v111
    v_cvt_pk_bf16_f32 v52, v112, v113
    v_cvt_pk_bf16_f32 v53, v114, v115
    v_cvt_pk_bf16_f32 v54, v116, v117
    v_cvt_pk_bf16_f32 v55, v118, v119
    v_exp_f32 v120, v120
    v_exp_f32 v121, v121
    v_exp_f32 v122, v122
    v_exp_f32 v123, v123
    v_exp_f32 v124, v124
    v_exp_f32 v125, v125
    v_exp_f32 v126, v126
    v_exp_f32 v127, v127
    v_exp_f32 v128, v128
    v_exp_f32 v129, v129
    v_exp_f32 v130, v130
    v_exp_f32 v131, v131
    v_exp_f32 v132, v132
    v_exp_f32 v133, v133
    v_exp_f32 v134, v134
    v_exp_f32 v135, v135
    v_pk_add_f32 v[120:121], v[120:121], 1.0 op_sel_hi:[1,0]
    v_pk_add_f32 v[122:123], v[122:123], 1.0 op_sel_hi:[1,0]
    v_pk_add_f32 v[124:125], v[124:125], 1.0 op_sel_hi:[1,0]
    v_pk_add_f32 v[126:127], v[126:127], 1.0 op_sel_hi:[1,0]
    v_pk_add_f32 v[128:129], v[128:129], 1.0 op_sel_hi:[1,0]
    v_pk_add_f32 v[130:131], v[130:131], 1.0 op_sel_hi:[1,0]
    v_pk_add_f32 v[132:133], v[132:133], 1.0 op_sel_hi:[1,0]
    v_pk_add_f32 v[134:135], v[134:135], 1.0 op_sel_hi:[1,0]
    v_rcp_f32 v120, v120
    v_rcp_f32 v121, v121
    v_rcp_f32 v122, v122
    v_rcp_f32 v123, v123
    v_rcp_f32 v124, v124
    v_mfma_f32_32x32x16_bf16 v[104:119], v[152:155], a[80:83], 0
    s_waitcnt vmcnt(0)
    ds_read_b128 v[24:27], v4 offset:4224
    ds_read_b128 v[28:31], v4 offset:4256
    ds_read_b128 v[32:35], v4 offset:4288
    ds_read_b128 v[36:39], v4 offset:4320
    v_rcp_f32 v125, v125
    v_rcp_f32 v126, v126
    v_mfma_f32_16x16x32_bf16 v[160:163], a[64:67], v[44:47], v[2:5]
    buffer_load_dwordx4 v164, s[24:27], 0 offen offset:0 nt lds
    buffer_load_dwordx4 v165, s[28:31], 0 offen offset:1056 nt lds
    buffer_load_dwordx4 v166, s[40:43], 0 offen offset:2112 nt lds
    buffer_load_dwordx4 v167, s[44:47], 0 offen offset:3168 nt lds
    v_mfma_f32_16x16x32_bf16 v[160:163], a[68:71], v[52:55], v[160:163]
    s_waitcnt lgkmcnt(3)
    v_rcp_f32 v127, v127
    v_mfma_f32_32x32x16_bf16 v[104:119], a[0:3], v[24:27], v[104:119]
    s_waitcnt lgkmcnt(2)
    v_rcp_f32 v128, v128
    v_cvt_pk_bf16_f32 v60, v120, v121
    v_cvt_pk_bf16_f32 v61, v122, v123
    v_cvt_pk_bf16_f32 v62, v124, v125
    v_cvt_pk_bf16_f32 v63, v126, v127
    v_mfma_f32_32x32x16_bf16 v[104:119], a[4:7], v[28:31], v[104:119]
    s_waitcnt lgkmcnt(0)
    v_rcp_f32 v129, v129
    v_rcp_f32 v130, v130
    v_rcp_f32 v131, v131
    v_mfma_f32_16x16x32_bf16 v[160:163], a[72:75], v[60:63], v[160:163]
    v_rcp_f32 v132, v132
    v_mfma_f32_32x32x16_bf16 v[104:119], a[8:11], v[32:35], v[104:119]
    v_rcp_f32 v133, v133
    v_rcp_f32 v134, v134
    v_rcp_f32 v135, v135
    v_mfma_f32_32x32x16_bf16 v[104:119], a[12:15], v[36:39], v[104:119]
    v_cvt_pk_bf16_f32 v68, v128, v129
    v_cvt_pk_bf16_f32 v69, v130, v131
    v_cvt_pk_bf16_f32 v70, v132, v133
    v_cvt_pk_bf16_f32 v71, v134, v135
    v_and_b32_e64 v14, s79, v12
    v_lshl_add_u32 v16, v14, 2, v8
    v_mfma_f32_16x16x32_bf16 v[160:163], a[76:79], v[68:71], v[160:163]
    v_mad_u32_u24 v23, v14, s37, v11
    v_and_or_b32 v168, v168, s22, v3
    v_and_or_b32 v169, v169, s22, v3
    v_and_or_b32 v170, v170, s22, v3
    v_and_or_b32 v171, v171, s22, v3
L_p7:
    v_dot2_f32_bf16 v40, v24, v72, 0
    v_dot2_f32_bf16 v41, v24, v76, 0
    v_dot2_f32_bf16 v42, v25, v73, 0
    v_dot2_f32_bf16 v43, v25, v77, 0
    v_dot2_f32_bf16 v44, v26, v74, 0
    v_dot2_f32_bf16 v45, v26, v78, 0
    v_dot2_f32_bf16 v46, v27, v75, 0
    v_dot2_f32_bf16 v47, v27, v79, 0
    v_mul_f32_e64 v19, v160, v18
    v_dot2_f32_bf16 v48, v28, v80, 0
    v_dot2_f32_bf16 v49, v28, v84, 0
    v_dot2_f32_bf16 v50, v29, v81, 0
    v_dot2_f32_bf16 v51, v29, v85, 0
    v_cvt_pk_bf16_f32 v19, v19, v19
    v_dot2_f32_bf16 v52, v30, v82, 0
    v_dot2_f32_bf16 v53, v30, v86, 0
    v_dot2_f32_bf16 v54, v31, v83, 0
    v_dot2_f32_bf16 v55, v31, v87, 0
    v_dot2_f32_bf16 v56, v32, v88, 0
    v_dot2_f32_bf16 v57, v32, v92, 0
    v_dot2_f32_bf16 v58, v33, v89, 0
    v_dot2_f32_bf16 v59, v33, v93, 0
    v_cvt_pk_bf16_f32 v40, v40, v41
    v_cvt_pk_bf16_f32 v41, v42, v43
    v_cvt_pk_bf16_f32 v42, v44, v45
    v_cvt_pk_bf16_f32 v43, v46, v47
    v_dot2_f32_bf16 v60, v34, v90, 0
    v_dot2_f32_bf16 v61, v34, v94, 0
    v_dot2_f32_bf16 v62, v35, v91, 0
    v_dot2_f32_bf16 v63, v35, v95, 0
    v_dot2_f32_bf16 v64, v36, v96, 0
    v_dot2_f32_bf16 v65, v36, v100, 0
    v_dot2_f32_bf16 v66, v37, v97, 0
    v_dot2_f32_bf16 v67, v37, v101, 0
    v_dot2_f32_bf16 v68, v38, v98, 0
    v_dot2_f32_bf16 v69, v38, v102, 0
    v_dot2_f32_bf16 v70, v39, v99, 0
    v_dot2_f32_bf16 v71, v39, v103, 0
    v_mfma_f32_32x32x16_bf16 v[104:119], a[32:35], v[40:43], v[104:119]
    v_cvt_pk_bf16_f32 v48, v48, v49
    v_cvt_pk_bf16_f32 v49, v50, v51
    v_cvt_pk_bf16_f32 v50, v52, v53
    v_cvt_pk_bf16_f32 v51, v54, v55
    v_cvt_pk_bf16_f32 v56, v56, v57
    v_cvt_pk_bf16_f32 v57, v58, v59
    v_mfma_f32_32x32x16_bf16 v[104:119], a[36:39], v[48:51], v[104:119]
    v_cvt_pk_bf16_f32 v58, v60, v61
    v_cvt_pk_bf16_f32 v59, v62, v63
    v_cvt_pk_bf16_f32 v64, v64, v65
    v_cvt_pk_bf16_f32 v65, v66, v67
    v_cvt_pk_bf16_f32 v66, v68, v69
    v_cvt_pk_bf16_f32 v67, v70, v71
    v_mfma_f32_32x32x16_bf16 v[104:119], a[40:43], v[56:59], v[104:119]
    ds_read_b64_tr_b16 v[72:73], v5 offset:0
    ds_read_b64_tr_b16 v[74:75], v5 offset:512
    ds_write_b16 v17, v19 offset:16464
    v_lshl_add_u32 v17, v15, 2, v9
    v_and_b32 v18, s36, v13
    v_mfma_f32_32x32x16_bf16 v[104:119], a[44:47], v[64:67], v[104:119]
    s_nop 0
    ds_read_b64_tr_b16 v[76:77], v5 offset:32
    ds_read_b64_tr_b16 v[78:79], v5 offset:544
    ds_read_b64_tr_b16 v[80:81], v5 offset:64
    ds_read_b64_tr_b16 v[82:83], v5 offset:576
    ds_read_b64_tr_b16 v[84:85], v5 offset:96
    ds_read_b64_tr_b16 v[86:87], v5 offset:608
    v_mfma_f32_32x32x16_bf16 v[120:135], v[156:159], a[80:83], 0
    ds_read_b128 v[88:91], v10 offset:16464
    ds_read_b32 v13, v6 offset:1152
    ds_read_b128 a[80:83], v16
    s_nop 0
    v_exp_f32 v104, v104
    v_mfma_f32_32x32x16_bf16 v[120:135], a[16:19], v[24:27], v[120:135]
    v_exp_f32 v105, v105
    v_exp_f32 v106, v106
    v_exp_f32 v107, v107
    v_mfma_f32_32x32x16_bf16 v[120:135], a[20:23], v[28:31], v[120:135]
    v_exp_f32 v108, v108
    v_exp_f32 v109, v109
    v_exp_f32 v110, v110
    v_mfma_f32_32x32x16_bf16 v[120:135], a[24:27], v[32:35], v[120:135]
    v_exp_f32 v111, v111
    v_exp_f32 v112, v112
    v_exp_f32 v113, v113
    v_mfma_f32_32x32x16_bf16 v[120:135], a[28:31], v[36:39], v[120:135]
    v_exp_f32 v114, v114
    v_exp_f32 v115, v115
    v_exp_f32 v116, v116
    v_exp_f32 v117, v117
    v_exp_f32 v118, v118
    v_exp_f32_e64 v119, v119
    v_pk_add_f32 v[104:105], v[104:105], 1.0 op_sel_hi:[1,0]
    v_pk_add_f32 v[106:107], v[106:107], 1.0 op_sel_hi:[1,0]
    v_pk_add_f32 v[108:109], v[108:109], 1.0 op_sel_hi:[1,0]
    v_pk_add_f32 v[110:111], v[110:111], 1.0 op_sel_hi:[1,0]
    v_pk_add_f32 v[112:113], v[112:113], 1.0 op_sel_hi:[1,0]
    v_pk_add_f32 v[114:115], v[114:115], 1.0 op_sel_hi:[1,0]
    v_pk_add_f32 v[116:117], v[116:117], 1.0 op_sel_hi:[1,0]
    v_pk_add_f32 v[118:119], v[118:119], 1.0 op_sel_hi:[1,0]
    v_mfma_f32_32x32x16_bf16 v[120:135], a[48:51], v[40:43], v[120:135]
    s_waitcnt lgkmcnt(0)
    v_rcp_f32 v104, v104
    v_rcp_f32 v105, v105
    v_rcp_f32 v106, v106
    v_mfma_f32_32x32x16_bf16 v[120:135], a[52:55], v[48:51], v[120:135]
    s_add_u32 m0, s34, 0
    v_rcp_f32 v107, v107
    v_rcp_f32 v108, v108
    v_rcp_f32 v109, v109
    v_mfma_f32_32x32x16_bf16 v[120:135], a[56:59], v[56:59], v[120:135]
    v_rcp_f32 v110, v110
    v_rcp_f32 v111, v111
    v_rcp_f32 v112, v112
    v_mfma_f32_32x32x16_bf16 v[120:135], a[60:63], v[64:67], v[120:135]
    v_rcp_f32 v113, v113
    v_rcp_f32 v114, v114
    v_rcp_f32 v115, v115
    v_mfma_f32_16x16x32_bf16 v[136:139], v[72:75], v[88:91], v[136:139]
    v_rcp_f32 v116, v116
    v_mfma_f32_16x16x32_bf16 v[140:143], v[76:79], v[88:91], v[140:143]
    v_rcp_f32 v117, v117
    v_mfma_f32_16x16x32_bf16 v[144:147], v[80:83], v[88:91], v[144:147]
    v_rcp_f32_e64 v118, v118
    v_mfma_f32_16x16x32_bf16 v[148:151], v[84:87], v[88:91], v[148:151]
    ds_read_b128 v[72:75], v23 offset:4224
    ds_read_b128 v[76:79], v23 offset:4352
    ds_read_b128 v[80:83], v23 offset:4256
    ds_read_b128 v[84:87], v23 offset:4384
    ds_read_b128 v[88:91], v23 offset:4288
    ds_read_b128 v[92:95], v23 offset:4416
    ds_read_b128 v[96:99], v23 offset:4320
    ds_read_b128 v[100:103], v23 offset:4448
    v_rcp_f32_e64 v119, v119
    v_cvt_pk_bf16_f32 v44, v104, v105
    v_cvt_pk_bf16_f32 v45, v106, v107
    v_cvt_pk_bf16_f32 v46, v108, v109
    v_cvt_pk_bf16_f32 v47, v110, v111
    v_cvt_pk_bf16_f32 v52, v112, v113
    v_cvt_pk_bf16_f32 v53, v114, v115
    v_cvt_pk_bf16_f32 v54, v116, v117
    v_cvt_pk_bf16_f32 v55, v118, v119
    v_exp_f32 v120, v120
    v_exp_f32 v121, v121
    v_exp_f32 v122, v122
    v_exp_f32 v123, v123
    v_exp_f32 v124, v124
    v_exp_f32 v125, v125
    v_exp_f32 v126, v126
    v_exp_f32 v127, v127
    v_exp_f32 v128, v128
    v_exp_f32 v129, v129
    v_exp_f32 v130, v130
    v_exp_f32 v131, v131
    v_exp_f32 v132, v132
    v_exp_f32 v133, v133
    v_exp_f32 v134, v134
    v_exp_f32 v135, v135
    v_pk_add_f32 v[120:121], v[120:121], 1.0 op_sel_hi:[1,0]
    v_pk_add_f32 v[122:123], v[122:123], 1.0 op_sel_hi:[1,0]
    v_pk_add_f32 v[124:125], v[124:125], 1.0 op_sel_hi:[1,0]
    v_pk_add_f32 v[126:127], v[126:127], 1.0 op_sel_hi:[1,0]
    v_pk_add_f32 v[128:129], v[128:129], 1.0 op_sel_hi:[1,0]
    v_pk_add_f32 v[130:131], v[130:131], 1.0 op_sel_hi:[1,0]
    v_pk_add_f32 v[132:133], v[132:133], 1.0 op_sel_hi:[1,0]
    v_pk_add_f32 v[134:135], v[134:135], 1.0 op_sel_hi:[1,0]
    v_rcp_f32 v120, v120
    v_rcp_f32 v121, v121
    v_rcp_f32 v122, v122
    v_rcp_f32 v123, v123
    v_rcp_f32 v124, v124
    v_mfma_f32_32x32x16_bf16 v[104:119], v[152:155], a[80:83], 0
    s_waitcnt vmcnt(0)
    ds_read_b128 v[24:27], v4 offset:8448
    ds_read_b128 v[28:31], v4 offset:8480
    ds_read_b128 v[32:35], v4 offset:8512
    ds_read_b128 v[36:39], v4 offset:8544
    v_rcp_f32 v125, v125
    v_rcp_f32 v126, v126
    v_mfma_f32_16x16x32_bf16 v[160:163], a[64:67], v[44:47], v[2:5]
    buffer_load_dwordx4 v168, s[24:27], 0 offen offset:0 nt lds
    buffer_load_dwordx4 v169, s[28:31], 0 offen offset:1056 nt lds
    buffer_load_dwordx4 v170, s[40:43], 0 offen offset:2112 nt lds
    buffer_load_dwordx4 v171, s[44:47], 0 offen offset:3168 nt lds
    v_mfma_f32_16x16x32_bf16 v[160:163], a[68:71], v[52:55], v[160:163]
    s_waitcnt lgkmcnt(3)
    v_rcp_f32 v127, v127
    v_mfma_f32_32x32x16_bf16 v[104:119], a[0:3], v[24:27], v[104:119]
    s_waitcnt lgkmcnt(2)
    v_rcp_f32 v128, v128
    v_cvt_pk_bf16_f32 v60, v120, v121
    v_cvt_pk_bf16_f32 v61, v122, v123
    v_cvt_pk_bf16_f32 v62, v124, v125
    v_cvt_pk_bf16_f32 v63, v126, v127
    v_mfma_f32_32x32x16_bf16 v[104:119], a[4:7], v[28:31], v[104:119]
    s_waitcnt lgkmcnt(0)
    v_rcp_f32 v129, v129
    v_rcp_f32 v130, v130
    v_rcp_f32 v131, v131
    v_mfma_f32_16x16x32_bf16 v[160:163], a[72:75], v[60:63], v[160:163]
    v_rcp_f32 v132, v132
    v_mfma_f32_32x32x16_bf16 v[104:119], a[8:11], v[32:35], v[104:119]
    v_rcp_f32 v133, v133
    v_rcp_f32 v134, v134
    v_rcp_f32 v135, v135
    v_mfma_f32_32x32x16_bf16 v[104:119], a[12:15], v[36:39], v[104:119]
    v_cvt_pk_bf16_f32 v68, v128, v129
    v_cvt_pk_bf16_f32 v69, v130, v131
    v_cvt_pk_bf16_f32 v70, v132, v133
    v_cvt_pk_bf16_f32 v71, v134, v135
    v_and_b32_e64 v15, s79, v13
    v_lshl_add_u32 v16, v15, 2, v8
    v_mfma_f32_16x16x32_bf16 v[160:163], a[76:79], v[68:71], v[160:163]
    v_mad_u32_u24 v23, v15, s37, v11
L_p8:
    v_dot2_f32_bf16 v40, v24, v72, 0
    v_dot2_f32_bf16 v41, v24, v76, 0
    v_dot2_f32_bf16 v42, v25, v73, 0
    v_dot2_f32_bf16 v43, v25, v77, 0
    v_dot2_f32_bf16 v44, v26, v74, 0
    v_dot2_f32_bf16 v45, v26, v78, 0
    v_dot2_f32_bf16 v46, v27, v75, 0
    v_dot2_f32_bf16 v47, v27, v79, 0
    v_mul_f32_e64 v19, v160, v18
    v_dot2_f32_bf16 v48, v28, v80, 0
    v_dot2_f32_bf16 v49, v28, v84, 0
    v_dot2_f32_bf16 v50, v29, v81, 0
    v_dot2_f32_bf16 v51, v29, v85, 0
    v_cvt_pk_bf16_f32 v19, v19, v19
    v_dot2_f32_bf16 v52, v30, v82, 0
    v_dot2_f32_bf16 v53, v30, v86, 0
    v_dot2_f32_bf16 v54, v31, v83, 0
    v_dot2_f32_bf16 v55, v31, v87, 0
    v_dot2_f32_bf16 v56, v32, v88, 0
    v_dot2_f32_bf16 v57, v32, v92, 0
    v_dot2_f32_bf16 v58, v33, v89, 0
    v_dot2_f32_bf16 v59, v33, v93, 0
    v_cvt_pk_bf16_f32 v40, v40, v41
    v_cvt_pk_bf16_f32 v41, v42, v43
    v_cvt_pk_bf16_f32 v42, v44, v45
    v_cvt_pk_bf16_f32 v43, v46, v47
    v_dot2_f32_bf16 v60, v34, v90, 0
    v_dot2_f32_bf16 v61, v34, v94, 0
    v_dot2_f32_bf16 v62, v35, v91, 0
    v_dot2_f32_bf16 v63, v35, v95, 0
    v_dot2_f32_bf16 v64, v36, v96, 0
    v_dot2_f32_bf16 v65, v36, v100, 0
    v_dot2_f32_bf16 v66, v37, v97, 0
    v_dot2_f32_bf16 v67, v37, v101, 0
    v_dot2_f32_bf16 v68, v38, v98, 0
    v_dot2_f32_bf16 v69, v38, v102, 0
    v_dot2_f32_bf16 v70, v39, v99, 0
    v_dot2_f32_bf16 v71, v39, v103, 0
    v_mfma_f32_32x32x16_bf16 v[104:119], a[32:35], v[40:43], v[104:119]
    v_cvt_pk_bf16_f32 v48, v48, v49
    v_cvt_pk_bf16_f32 v49, v50, v51
    v_cvt_pk_bf16_f32 v50, v52, v53
    v_cvt_pk_bf16_f32 v51, v54, v55
    v_cvt_pk_bf16_f32 v56, v56, v57
    v_cvt_pk_bf16_f32 v57, v58, v59
    v_mfma_f32_32x32x16_bf16 v[104:119], a[36:39], v[48:51], v[104:119]
    v_cvt_pk_bf16_f32 v58, v60, v61
    v_cvt_pk_bf16_f32 v59, v62, v63
    v_cvt_pk_bf16_f32 v64, v64, v65
    v_cvt_pk_bf16_f32 v65, v66, v67
    v_cvt_pk_bf16_f32 v66, v68, v69
    v_cvt_pk_bf16_f32 v67, v70, v71
    v_mfma_f32_32x32x16_bf16 v[104:119], a[40:43], v[56:59], v[104:119]
    ds_read_b64_tr_b16 v[72:73], v5 offset:4224
    ds_read_b64_tr_b16 v[74:75], v5 offset:4736
    ds_write_b16 v17, v19 offset:17552
    v_lshl_add_u32 v17, v14, 2, v9
    v_and_b32 v18, s36, v12
    v_mfma_f32_32x32x16_bf16 v[104:119], a[44:47], v[64:67], v[104:119]
    s_nop 0
    ds_read_b64_tr_b16 v[76:77], v5 offset:4256
    ds_read_b64_tr_b16 v[78:79], v5 offset:4768
    ds_read_b64_tr_b16 v[80:81], v5 offset:4288
    ds_read_b64_tr_b16 v[82:83], v5 offset:4800
    ds_read_b64_tr_b16 v[84:85], v5 offset:4320
    ds_read_b64_tr_b16 v[86:87], v5 offset:4832
    v_mfma_f32_32x32x16_bf16 v[120:135], v[156:159], a[80:83], 0
    ds_read_b128 v[88:91], v10 offset:17552
    ds_read_b128 a[80:83], v16
    s_nop 1
    v_exp_f32 v104, v104
    v_mfma_f32_32x32x16_bf16 v[120:135], a[16:19], v[24:27], v[120:135]
    v_exp_f32 v105, v105
    v_exp_f32 v106, v106
    v_exp_f32 v107, v107
    v_mfma_f32_32x32x16_bf16 v[120:135], a[20:23], v[28:31], v[120:135]
    v_exp_f32 v108, v108
    v_exp_f32 v109, v109
    v_exp_f32 v110, v110
    v_mfma_f32_32x32x16_bf16 v[120:135], a[24:27], v[32:35], v[120:135]
    v_exp_f32 v111, v111
    v_exp_f32 v112, v112
    v_exp_f32 v113, v113
    v_mfma_f32_32x32x16_bf16 v[120:135], a[28:31], v[36:39], v[120:135]
    v_exp_f32 v114, v114
    v_exp_f32 v115, v115
    v_exp_f32 v116, v116
    v_exp_f32 v117, v117
    v_exp_f32 v118, v118
    v_exp_f32_e64 v119, v119
    v_pk_add_f32 v[104:105], v[104:105], 1.0 op_sel_hi:[1,0]
    v_pk_add_f32 v[106:107], v[106:107], 1.0 op_sel_hi:[1,0]
    v_pk_add_f32 v[108:109], v[108:109], 1.0 op_sel_hi:[1,0]
    v_pk_add_f32 v[110:111], v[110:111], 1.0 op_sel_hi:[1,0]
    v_pk_add_f32 v[112:113], v[112:113], 1.0 op_sel_hi:[1,0]
    v_pk_add_f32 v[114:115], v[114:115], 1.0 op_sel_hi:[1,0]
    v_pk_add_f32 v[116:117], v[116:117], 1.0 op_sel_hi:[1,0]
    v_pk_add_f32 v[118:119], v[118:119], 1.0 op_sel_hi:[1,0]
    v_mfma_f32_32x32x16_bf16 v[120:135], a[48:51], v[40:43], v[120:135]
    s_waitcnt lgkmcnt(0)
    v_rcp_f32 v104, v104
    v_rcp_f32 v105, v105
    v_rcp_f32 v106, v106
    v_mfma_f32_32x32x16_bf16 v[120:135], a[52:55], v[48:51], v[120:135]
    v_rcp_f32 v107, v107
    v_rcp_f32 v108, v108
    v_rcp_f32 v109, v109
    v_mfma_f32_32x32x16_bf16 v[120:135], a[56:59], v[56:59], v[120:135]
    v_rcp_f32 v110, v110
    v_rcp_f32 v111, v111
    v_rcp_f32 v112, v112
    v_mfma_f32_32x32x16_bf16 v[120:135], a[60:63], v[64:67], v[120:135]
    v_rcp_f32 v113, v113
    v_rcp_f32 v114, v114
    v_rcp_f32 v115, v115
    v_mfma_f32_16x16x32_bf16 v[136:139], v[72:75], v[88:91], v[136:139]
    v_rcp_f32 v116, v116
    v_mfma_f32_16x16x32_bf16 v[140:143], v[76:79], v[88:91], v[140:143]
    v_rcp_f32 v117, v117
    v_mfma_f32_16x16x32_bf16 v[144:147], v[80:83], v[88:91], v[144:147]
    v_rcp_f32 v118, v118
    v_mfma_f32_16x16x32_bf16 v[148:151], v[84:87], v[88:91], v[148:151]
    ds_read_b128 v[72:75], v23 offset:4224
    ds_read_b128 v[76:79], v23 offset:4352
    ds_read_b128 v[80:83], v23 offset:4256
    ds_read_b128 v[84:87], v23 offset:4384
    ds_read_b128 v[88:91], v23 offset:4288
    ds_read_b128 v[92:95], v23 offset:4416
    ds_read_b128 v[96:99], v23 offset:4320
    ds_read_b128 v[100:103], v23 offset:4448
    v_rcp_f32_e64 v119, v119
    v_cvt_pk_bf16_f32 v44, v104, v105
    v_cvt_pk_bf16_f32 v45, v106, v107
    v_cvt_pk_bf16_f32 v46, v108, v109
    v_cvt_pk_bf16_f32 v47, v110, v111
    v_cvt_pk_bf16_f32 v52, v112, v113
    v_cvt_pk_bf16_f32 v53, v114, v115
    v_cvt_pk_bf16_f32 v54, v116, v117
    v_cvt_pk_bf16_f32 v55, v118, v119
    v_exp_f32 v120, v120
    v_exp_f32 v121, v121
    v_exp_f32 v122, v122
    v_exp_f32 v123, v123
    v_exp_f32 v124, v124
    v_exp_f32 v125, v125
    v_exp_f32 v126, v126
    v_exp_f32 v127, v127
    v_exp_f32 v128, v128
    v_exp_f32 v129, v129
    v_exp_f32 v130, v130
    v_exp_f32 v131, v131
    v_exp_f32 v132, v132
    v_exp_f32 v133, v133
    v_exp_f32 v134, v134
    v_exp_f32 v135, v135
    v_pk_add_f32 v[120:121], v[120:121], 1.0 op_sel_hi:[1,0]
    v_pk_add_f32 v[122:123], v[122:123], 1.0 op_sel_hi:[1,0]
    v_pk_add_f32 v[124:125], v[124:125], 1.0 op_sel_hi:[1,0]
    v_pk_add_f32 v[126:127], v[126:127], 1.0 op_sel_hi:[1,0]
    v_pk_add_f32 v[128:129], v[128:129], 1.0 op_sel_hi:[1,0]
    v_pk_add_f32 v[130:131], v[130:131], 1.0 op_sel_hi:[1,0]
    v_pk_add_f32 v[132:133], v[132:133], 1.0 op_sel_hi:[1,0]
    v_pk_add_f32 v[134:135], v[134:135], 1.0 op_sel_hi:[1,0]
    v_rcp_f32 v120, v120
    v_rcp_f32 v121, v121
    v_rcp_f32 v122, v122
    v_mfma_f32_32x32x16_bf16 v[104:119], v[152:155], a[80:83], 0
    s_waitcnt vmcnt(0)
    ds_read_b128 v[24:27], v4 offset:0
    ds_read_b128 v[28:31], v4 offset:32
    ds_read_b128 v[32:35], v4 offset:64
    ds_read_b128 v[36:39], v4 offset:96
    v_rcp_f32 v123, v123
    v_rcp_f32 v124, v124
    v_rcp_f32 v125, v125
    v_mfma_f32_16x16x32_bf16 v[160:163], a[64:67], v[44:47], v[2:5]
    v_rcp_f32 v126, v126
    v_mfma_f32_16x16x32_bf16 v[160:163], a[68:71], v[52:55], v[160:163]
    s_waitcnt lgkmcnt(3)
    v_rcp_f32 v127, v127
    v_mfma_f32_32x32x16_bf16 v[104:119], a[0:3], v[24:27], v[104:119]
    s_waitcnt lgkmcnt(2)
    v_rcp_f32 v128, v128
    v_cvt_pk_bf16_f32 v60, v120, v121
    v_cvt_pk_bf16_f32 v61, v122, v123
    v_cvt_pk_bf16_f32 v62, v124, v125
    v_cvt_pk_bf16_f32 v63, v126, v127
    v_mfma_f32_32x32x16_bf16 v[104:119], a[4:7], v[28:31], v[104:119]
    s_waitcnt lgkmcnt(0)
    v_rcp_f32 v129, v129
    v_rcp_f32 v130, v130
    v_rcp_f32 v131, v131
    v_mfma_f32_16x16x32_bf16 v[160:163], a[72:75], v[60:63], v[160:163]
    v_rcp_f32 v132, v132
    v_mfma_f32_32x32x16_bf16 v[104:119], a[8:11], v[32:35], v[104:119]
    v_rcp_f32 v133, v133
    v_rcp_f32 v134, v134
    v_rcp_f32 v135, v135
    v_mfma_f32_32x32x16_bf16 v[104:119], a[12:15], v[36:39], v[104:119]
    v_cvt_pk_bf16_f32 v68, v128, v129
    v_cvt_pk_bf16_f32 v69, v130, v131
    v_cvt_pk_bf16_f32 v70, v132, v133
    v_cvt_pk_bf16_f32 v71, v134, v135
    s_nop 1
    v_mfma_f32_16x16x32_bf16 v[160:163], a[76:79], v[68:71], v[160:163]
L_p9:
    v_dot2_f32_bf16 v40, v24, v72, 0
    v_dot2_f32_bf16 v41, v24, v76, 0
    v_dot2_f32_bf16 v42, v25, v73, 0
    v_dot2_f32_bf16 v43, v25, v77, 0
    v_dot2_f32_bf16 v44, v26, v74, 0
    v_dot2_f32_bf16 v45, v26, v78, 0
    v_dot2_f32_bf16 v46, v27, v75, 0
    v_dot2_f32_bf16 v47, v27, v79, 0
    v_mul_f32 v19, v160, v18
    v_dot2_f32_bf16 v48, v28, v80, 0
    v_dot2_f32_bf16 v49, v28, v84, 0
    v_dot2_f32_bf16 v50, v29, v81, 0
    v_dot2_f32_bf16 v51, v29, v85, 0
    v_cvt_pk_bf16_f32 v19, v19, v19
    v_dot2_f32_bf16 v52, v30, v82, 0
    v_dot2_f32_bf16 v53, v30, v86, 0
    v_dot2_f32_bf16 v54, v31, v83, 0
    v_dot2_f32_bf16 v55, v31, v87, 0
    v_dot2_f32_bf16 v56, v32, v88, 0
    v_dot2_f32_bf16 v57, v32, v92, 0
    v_dot2_f32_bf16 v58, v33, v89, 0
    v_dot2_f32_bf16 v59, v33, v93, 0
    v_cvt_pk_bf16_f32 v40, v40, v41
    v_cvt_pk_bf16_f32 v41, v42, v43
    v_cvt_pk_bf16_f32 v42, v44, v45
    v_cvt_pk_bf16_f32 v43, v46, v47
    v_dot2_f32_bf16 v60, v34, v90, 0
    v_dot2_f32_bf16 v61, v34, v94, 0
    v_dot2_f32_bf16 v62, v35, v91, 0
    v_dot2_f32_bf16 v63, v35, v95, 0
    v_dot2_f32_bf16 v64, v36, v96, 0
    v_dot2_f32_bf16 v65, v36, v100, 0
    v_dot2_f32_bf16 v66, v37, v97, 0
    v_dot2_f32_bf16 v67, v37, v101, 0
    v_dot2_f32_bf16 v68, v38, v98, 0
    v_dot2_f32_bf16 v69, v38, v102, 0
    v_dot2_f32_bf16 v70, v39, v99, 0
    v_dot2_f32_bf16 v71, v39, v103, 0
    v_mfma_f32_32x32x16_bf16 v[104:119], a[32:35], v[40:43], v[104:119]
    v_cvt_pk_bf16_f32 v48, v48, v49
    v_cvt_pk_bf16_f32 v49, v50, v51
    v_cvt_pk_bf16_f32 v50, v52, v53
    v_cvt_pk_bf16_f32 v51, v54, v55
    v_cvt_pk_bf16_f32 v56, v56, v57
    v_cvt_pk_bf16_f32 v57, v58, v59
    v_mfma_f32_32x32x16_bf16 v[104:119], a[36:39], v[48:51], v[104:119]
    v_cvt_pk_bf16_f32 v58, v60, v61
    v_cvt_pk_bf16_f32 v59, v62, v63
    v_cvt_pk_bf16_f32 v64, v64, v65
    v_cvt_pk_bf16_f32 v65, v66, v67
    v_cvt_pk_bf16_f32 v66, v68, v69
    v_cvt_pk_bf16_f32 v67, v70, v71
    v_mfma_f32_32x32x16_bf16 v[104:119], a[40:43], v[56:59], v[104:119]
    ds_read_b64_tr_b16 v[72:73], v5 offset:8448
    ds_read_b64_tr_b16 v[74:75], v5 offset:8960
    ds_write_b16 v17, v19 offset:18640
    v_lshl_add_u32 v17, v15, 2, v9
    v_and_b32 v18, s36, v13
    v_mfma_f32_32x32x16_bf16 v[104:119], a[44:47], v[64:67], v[104:119]
    s_nop 0
    ds_read_b64_tr_b16 v[76:77], v5 offset:8480
    ds_read_b64_tr_b16 v[78:79], v5 offset:8992
    ds_read_b64_tr_b16 v[80:81], v5 offset:8512
    ds_read_b64_tr_b16 v[82:83], v5 offset:9024
    ds_read_b64_tr_b16 v[84:85], v5 offset:8544
    ds_read_b64_tr_b16 v[86:87], v5 offset:9056
    v_mfma_f32_32x32x16_bf16 v[120:135], v[156:159], a[80:83], 0
    ds_read_b128 v[88:91], v10 offset:18640
    ds_read_b64_tr_b16 v[92:93], v5 offset:0
    ds_read_b64_tr_b16 v[94:95], v5 offset:512
    ds_read_b64_tr_b16 v[96:97], v5 offset:32
    v_exp_f32_e64 v104, v104
    v_mfma_f32_32x32x16_bf16 v[120:135], a[16:19], v[24:27], v[120:135]
    ds_read_b64_tr_b16 v[98:99], v5 offset:544
    ds_read_b64_tr_b16 v[100:101], v5 offset:64
    v_exp_f32 v105, v105
    v_exp_f32 v106, v106
    v_mfma_f32_32x32x16_bf16 v[120:135], a[20:23], v[28:31], v[120:135]
    ds_read_b64_tr_b16 v[102:103], v5 offset:576
    ds_read_b64_tr_b16 v[164:165], v5 offset:96
    v_exp_f32 v107, v107
    v_exp_f32 v108, v108
    v_mfma_f32_32x32x16_bf16 v[120:135], a[24:27], v[32:35], v[120:135]
    ds_read_b64_tr_b16 v[166:167], v5 offset:608
    v_exp_f32 v109, v109
    v_exp_f32 v110, v110
    v_exp_f32 v111, v111
    v_mfma_f32_32x32x16_bf16 v[120:135], a[28:31], v[36:39], v[120:135]
    v_exp_f32 v112, v112
    v_exp_f32 v113, v113
    v_exp_f32 v114, v114
    v_exp_f32 v115, v115
    v_exp_f32 v116, v116
    v_exp_f32 v117, v117
    v_exp_f32 v118, v118
    v_exp_f32_e64 v119, v119
    v_pk_add_f32 v[104:105], v[104:105], 1.0 op_sel_hi:[1,0]
    v_pk_add_f32 v[106:107], v[106:107], 1.0 op_sel_hi:[1,0]
    v_pk_add_f32 v[108:109], v[108:109], 1.0 op_sel_hi:[1,0]
    v_pk_add_f32 v[110:111], v[110:111], 1.0 op_sel_hi:[1,0]
    v_pk_add_f32 v[112:113], v[112:113], 1.0 op_sel_hi:[1,0]
    v_pk_add_f32 v[114:115], v[114:115], 1.0 op_sel_hi:[1,0]
    v_pk_add_f32 v[116:117], v[116:117], 1.0 op_sel_hi:[1,0]
    v_pk_add_f32 v[118:119], v[118:119], 1.0 op_sel_hi:[1,0]
    v_mfma_f32_32x32x16_bf16 v[120:135], a[48:51], v[40:43], v[120:135]
    s_waitcnt lgkmcnt(0)
    v_rcp_f32 v104, v104
    v_rcp_f32 v105, v105
    v_rcp_f32 v106, v106
    v_mfma_f32_32x32x16_bf16 v[120:135], a[52:55], v[48:51], v[120:135]
    v_rcp_f32 v107, v107
    v_rcp_f32 v108, v108
    v_rcp_f32 v109, v109
    v_mfma_f32_32x32x16_bf16 v[120:135], a[56:59], v[56:59], v[120:135]
    v_rcp_f32 v110, v110
    v_rcp_f32 v111, v111
    v_rcp_f32 v112, v112
    v_mfma_f32_32x32x16_bf16 v[120:135], a[60:63], v[64:67], v[120:135]
    v_rcp_f32 v113, v113
    v_rcp_f32 v114, v114
    v_rcp_f32 v115, v115
    v_mfma_f32_16x16x32_bf16 v[136:139], v[72:75], v[88:91], v[136:139]
    v_rcp_f32 v116, v116
    v_mfma_f32_16x16x32_bf16 v[140:143], v[76:79], v[88:91], v[140:143]
    v_rcp_f32 v117, v117
    v_mfma_f32_16x16x32_bf16 v[144:147], v[80:83], v[88:91], v[144:147]
    v_rcp_f32 v118, v118
    v_mfma_f32_16x16x32_bf16 v[148:151], v[84:87], v[88:91], v[148:151]
    v_rcp_f32_e64 v119, v119
    v_cvt_pk_bf16_f32 v44, v104, v105
    v_cvt_pk_bf16_f32 v45, v106, v107
    v_cvt_pk_bf16_f32 v46, v108, v109
    v_cvt_pk_bf16_f32 v47, v110, v111
    v_cvt_pk_bf16_f32 v52, v112, v113
    v_cvt_pk_bf16_f32 v53, v114, v115
    v_cvt_pk_bf16_f32 v54, v116, v117
    v_cvt_pk_bf16_f32 v55, v118, v119
    v_exp_f32 v120, v120
    v_exp_f32 v121, v121
    v_exp_f32 v122, v122
    v_exp_f32 v123, v123
    v_exp_f32 v124, v124
    v_exp_f32 v125, v125
    v_exp_f32 v126, v126
    v_exp_f32 v127, v127
    v_exp_f32 v128, v128
    v_exp_f32 v129, v129
    v_exp_f32 v130, v130
    v_exp_f32 v131, v131
    v_exp_f32 v132, v132
    v_exp_f32 v133, v133
    v_exp_f32 v134, v134
    v_exp_f32 v135, v135
    v_pk_add_f32 v[120:121], v[120:121], 1.0 op_sel_hi:[1,0]
    v_pk_add_f32 v[122:123], v[122:123], 1.0 op_sel_hi:[1,0]
    v_pk_add_f32 v[124:125], v[124:125], 1.0 op_sel_hi:[1,0]
    v_pk_add_f32 v[126:127], v[126:127], 1.0 op_sel_hi:[1,0]
    v_pk_add_f32 v[128:129], v[128:129], 1.0 op_sel_hi:[1,0]
    v_pk_add_f32 v[130:131], v[130:131], 1.0 op_sel_hi:[1,0]
    v_pk_add_f32 v[132:133], v[132:133], 1.0 op_sel_hi:[1,0]
    v_pk_add_f32 v[134:135], v[134:135], 1.0 op_sel_hi:[1,0]
    v_rcp_f32 v120, v120
    v_rcp_f32 v121, v121
    v_rcp_f32 v122, v122
    v_rcp_f32 v123, v123
    v_rcp_f32 v124, v124
    v_rcp_f32 v125, v125
    v_rcp_f32 v126, v126
    v_rcp_f32 v127, v127
    v_rcp_f32 v128, v128
    v_rcp_f32 v129, v129
    v_rcp_f32 v130, v130
    v_rcp_f32 v131, v131
    v_rcp_f32 v132, v132
    v_rcp_f32 v133, v133
    v_rcp_f32 v134, v134
    v_rcp_f32 v135, v135
    v_cvt_pk_bf16_f32 v60, v120, v121
    v_cvt_pk_bf16_f32 v61, v122, v123
    v_cvt_pk_bf16_f32 v62, v124, v125
    v_cvt_pk_bf16_f32 v63, v126, v127
    v_mfma_f32_16x16x32_bf16 v[160:163], a[64:67], v[44:47], v[2:5]
    v_cvt_pk_bf16_f32 v68, v128, v129
    v_cvt_pk_bf16_f32 v69, v130, v131
    v_mfma_f32_16x16x32_bf16 v[160:163], a[68:71], v[52:55], v[160:163]
    v_cvt_pk_bf16_f32 v70, v132, v133
    v_cvt_pk_bf16_f32 v71, v134, v135
    v_mfma_f32_16x16x32_bf16 v[160:163], a[72:75], v[60:63], v[160:163]
    s_nop 0
    v_mfma_f32_16x16x32_bf16 v[160:163], a[76:79], v[68:71], v[160:163]
    v_and_b32 v16, 15, v0
    v_bfe_u32 v12, v0, 4, 2
    v_mad_u32_u24 v16, v16, 18, v12
    v_lshl_add_u32 v16, v16, 3, s34
    v_and_b32 v13, 63, v0
    v_lshrrev_b32 v12, 3, v13
    v_lshl_add_u32 v11, v13, 4, s51
    v_add_u32 v13, v12, v13
    v_mul_f32 v19, v160, v18
    v_cvt_pk_bf16_f32 v19, v19, v19
    ds_write_b16 v17, v19 offset:19728
    ds_read_b128 v[88:91], v10 offset:19728
    v_lshl_add_u32 v13, v13, 4, s34
    s_waitcnt lgkmcnt(0)
    v_mfma_f32_16x16x32_bf16 v[136:139], v[92:95], v[88:91], v[136:139]
    v_mfma_f32_16x16x32_bf16 v[140:143], v[96:99], v[88:91], v[140:143]
    v_mfma_f32_16x16x32_bf16 v[144:147], v[100:103], v[88:91], v[144:147]
    v_mfma_f32_16x16x32_bf16 v[148:151], v[164:167], v[88:91], v[148:151]
    s_nop 4
    v_cvt_pk_bf16_f32 v104, v136, v137
    v_cvt_pk_bf16_f32 v105, v138, v139
    v_cvt_pk_bf16_f32 v106, v140, v141
    v_cvt_pk_bf16_f32 v107, v142, v143
    ds_write2_b64 v16, v[104:105], v[106:107] offset0:0 offset1:4
    v_cvt_pk_bf16_f32 v108, v144, v145
    v_cvt_pk_bf16_f32 v109, v146, v147
    v_cvt_pk_bf16_f32 v110, v148, v149
    v_cvt_pk_bf16_f32 v111, v150, v151
    ds_write2_b64 v16, v[108:109], v[110:111] offset0:8 offset1:12
    ds_read_b128 v[112:115], v13
    ds_read_b128 v[116:119], v13 offset:1152
    s_waitcnt lgkmcnt(1)
    global_store_dwordx4 v11, v[112:115], s[18:19] sc1
    s_waitcnt lgkmcnt(0)
    global_store_dwordx4 v11, v[116:119], s[18:19] offset:1024 sc1
L_end:
    s_endpgm
L_e5:
    s_barrier
    s_barrier
    s_waitcnt vmcnt(4)
    ds_read_b128 v[24:27], v4 offset:8448
    ds_read_b128 v[28:31], v4 offset:8480
    ds_read_b128 v[32:35], v4 offset:8512
    ds_read_b128 v[36:39], v4 offset:8544
    ds_read_b32 v12, v6 offset:768
    ds_read_b128 v[168:171], v7 offset:896
    s_add_u32 m0, s34, 4224
    v_mfma_f32_32x32x16_bf16 v[120:135], v[156:159], a[80:83], 0
    s_waitcnt lgkmcnt(2)
    v_mfma_f32_32x32x16_bf16 v[104:119], a[0:3], v[24:27], v[104:119]
    v_lshlrev_b32 v40, 16, v24
    v_and_b32 v41, s36, v24
    v_lshlrev_b32 v42, 16, v25
    v_and_b32 v43, s36, v25
    v_lshlrev_b32 v44, 16, v26
    v_and_b32 v45, s36, v26
    v_mfma_f32_32x32x16_bf16 v[104:119], a[4:7], v[28:31], v[104:119]
    v_lshlrev_b32 v46, 16, v27
    v_and_b32 v47, s36, v27
    v_lshlrev_b32 v48, 16, v28
    v_and_b32 v49, s36, v28
    v_lshlrev_b32 v50, 16, v29
    v_and_b32 v51, s36, v29
    v_mfma_f32_32x32x16_bf16 v[104:119], a[8:11], v[32:35], v[104:119]
    v_lshlrev_b32 v52, 16, v30
    v_and_b32 v53, s36, v30
    v_lshlrev_b32 v54, 16, v31
    v_and_b32 v55, s36, v31
    v_lshlrev_b32 v56, 16, v32
    v_and_b32 v57, s36, v32
    v_mfma_f32_32x32x16_bf16 v[104:119], a[12:15], v[36:39], v[104:119]
    s_waitcnt lgkmcnt(0)
    v_lshlrev_b32 v58, 16, v33
    v_and_b32 v59, s36, v33
    v_lshlrev_b32 v60, 16, v34
    v_and_b32 v61, s36, v34
    v_lshlrev_b32 v62, 16, v35
    v_and_b32 v63, s36, v35
    v_mfma_f32_32x32x16_bf16 v[120:135], a[16:19], v[24:27], v[120:135]
    v_lshlrev_b32 v64, 16, v36
    v_and_b32 v65, s36, v36
    v_lshlrev_b32 v66, 16, v37
    v_and_b32 v67, s36, v37
    v_lshlrev_b32 v68, 16, v38
    v_and_b32 v69, s36, v38
    v_lshlrev_b32 v70, 16, v39
    v_and_b32 v71, s36, v39
    v_and_b32_e64 v14, s79, v12
    v_pk_mul_f32 v[40:41], v[40:41], v[72:73]
    v_pk_mul_f32 v[42:43], v[42:43], v[74:75]
    v_pk_mul_f32 v[44:45], v[44:45], v[76:77]
    v_pk_mul_f32 v[46:47], v[46:47], v[78:79]
    v_pk_mul_f32 v[48:49], v[48:49], v[80:81]
    v_pk_mul_f32 v[50:51], v[50:51], v[82:83]
    v_pk_mul_f32 v[52:53], v[52:53], v[84:85]
    v_pk_mul_f32 v[54:55], v[54:55], v[86:87]
    v_cvt_pk_bf16_f32 v40, v40, v41
    v_cvt_pk_bf16_f32 v41, v42, v43
    v_cvt_pk_bf16_f32 v42, v44, v45
    v_cvt_pk_bf16_f32 v43, v46, v47
    v_pk_mul_f32 v[56:57], v[56:57], v[88:89]
    v_pk_mul_f32 v[58:59], v[58:59], v[90:91]
    v_pk_mul_f32 v[60:61], v[60:61], v[92:93]
    v_pk_mul_f32 v[62:63], v[62:63], v[94:95]
    v_pk_mul_f32 v[64:65], v[64:65], v[96:97]
    v_pk_mul_f32 v[66:67], v[66:67], v[98:99]
    v_pk_mul_f32 v[68:69], v[68:69], v[100:101]
    v_pk_mul_f32 v[70:71], v[70:71], v[102:103]
    v_mfma_f32_32x32x16_bf16 v[104:119], a[32:35], v[40:43], v[104:119]
    v_cvt_pk_bf16_f32 v48, v48, v49
    v_cvt_pk_bf16_f32 v49, v50, v51
    v_cvt_pk_bf16_f32 v50, v52, v53
    v_cvt_pk_bf16_f32 v51, v54, v55
    v_cvt_pk_bf16_f32 v56, v56, v57
    v_cvt_pk_bf16_f32 v57, v58, v59
    v_mfma_f32_32x32x16_bf16 v[104:119], a[36:39], v[48:51], v[104:119]
    v_cvt_pk_bf16_f32 v58, v60, v61
    v_cvt_pk_bf16_f32 v59, v62, v63
    v_cvt_pk_bf16_f32 v64, v64, v65
    v_cvt_pk_bf16_f32 v65, v66, v67
    v_cvt_pk_bf16_f32 v66, v68, v69
    v_cvt_pk_bf16_f32 v67, v70, v71
    v_mfma_f32_32x32x16_bf16 v[104:119], a[40:43], v[56:59], v[104:119]
    v_lshl_add_u32 v16, v14, 2, v8
    v_lshl_add_u32 v17, v15, 2, v9
    v_and_b32_e64 v18, s36, v13
    v_mfma_f32_32x32x16_bf16 v[104:119], a[44:47], v[64:67], v[104:119]
    ds_read_b128 a[80:83], v16
    v_and_or_b32 v168, v168, s22, v3
    v_and_or_b32 v169, v169, s22, v3
    v_and_or_b32 v170, v170, s22, v3
    v_and_or_b32 v171, v171, s22, v3
    v_mad_u32_u24 v23, v14, s37, v11
    v_mfma_f32_32x32x16_bf16 v[120:135], a[20:23], v[28:31], v[120:135]
    s_nop 0
    ds_read_b32 v13, v6 offset:896
    ds_read_b128 v[164:167], v7 offset:1024
    s_nop 1
    v_exp_f32 v104, v104
    v_mfma_f32_32x32x16_bf16 v[120:135], a[24:27], v[32:35], v[120:135]
    v_exp_f32 v105, v105
    v_exp_f32 v106, v106
    v_exp_f32 v107, v107
    v_mfma_f32_32x32x16_bf16 v[120:135], a[28:31], v[36:39], v[120:135]
    v_exp_f32 v108, v108
    v_exp_f32 v109, v109
    v_exp_f32 v110, v110
    v_mfma_f32_32x32x16_bf16 v[120:135], a[48:51], v[40:43], v[120:135]
    v_exp_f32 v111, v111
    v_exp_f32 v112, v112
    v_exp_f32 v113, v113
    v_mfma_f32_32x32x16_bf16 v[120:135], a[52:55], v[48:51], v[120:135]
    v_exp_f32 v114, v114
    v_exp_f32 v115, v115
    v_exp_f32 v116, v116
    v_exp_f32 v117, v117
    v_exp_f32 v118, v118
    v_exp_f32 v119, v119
    v_pk_add_f32 v[104:105], v[104:105], 1.0 op_sel_hi:[1,0]
    v_pk_add_f32 v[106:107], v[106:107], 1.0 op_sel_hi:[1,0]
    v_pk_add_f32 v[108:109], v[108:109], 1.0 op_sel_hi:[1,0]
    v_pk_add_f32 v[110:111], v[110:111], 1.0 op_sel_hi:[1,0]
    v_pk_add_f32 v[112:113], v[112:113], 1.0 op_sel_hi:[1,0]
    v_pk_add_f32 v[114:115], v[114:115], 1.0 op_sel_hi:[1,0]
    v_pk_add_f32 v[116:117], v[116:117], 1.0 op_sel_hi:[1,0]
    v_pk_add_f32 v[118:119], v[118:119], 1.0 op_sel_hi:[1,0]
    v_mfma_f32_32x32x16_bf16 v[120:135], a[56:59], v[56:59], v[120:135]
    s_waitcnt lgkmcnt(0)
    v_rcp_f32 v104, v104
    v_rcp_f32 v105, v105
    v_rcp_f32 v106, v106
    v_mfma_f32_32x32x16_bf16 v[120:135], a[60:63], v[64:67], v[120:135]
    ds_read_b128 v[72:75], v23 offset:4224
    ds_read_b128 v[76:79], v23 offset:4352
    ds_read_b128 v[80:83], v23 offset:4256
    ds_read_b128 v[84:87], v23 offset:4384
    ds_read_b128 v[88:91], v23 offset:4288
    ds_read_b128 v[92:95], v23 offset:4416
    ds_read_b128 v[96:99], v23 offset:4320
    ds_read_b128 v[100:103], v23 offset:4448
    v_rcp_f32 v107, v107
    v_rcp_f32 v108, v108
    v_rcp_f32 v109, v109
    v_rcp_f32 v110, v110
    v_rcp_f32 v111, v111
    v_rcp_f32 v112, v112
    v_rcp_f32 v113, v113
    v_rcp_f32 v114, v114
    v_rcp_f32 v115, v115
    v_rcp_f32 v116, v116
    v_rcp_f32 v117, v117
    v_rcp_f32 v118, v118
    v_rcp_f32_e64 v119, v119
    v_cvt_pk_bf16_f32 v44, v104, v105
    v_cvt_pk_bf16_f32 v45, v106, v107
    v_cvt_pk_bf16_f32 v46, v108, v109
    v_cvt_pk_bf16_f32 v47, v110, v111
    v_cvt_pk_bf16_f32 v52, v112, v113
    v_cvt_pk_bf16_f32 v53, v114, v115
    v_cvt_pk_bf16_f32 v54, v116, v117
    v_cvt_pk_bf16_f32 v55, v118, v119
    v_exp_f32 v120, v120
    v_exp_f32 v121, v121
    v_exp_f32 v122, v122
    v_exp_f32 v123, v123
    v_exp_f32 v124, v124
    v_exp_f32 v125, v125
    v_exp_f32 v126, v126
    v_exp_f32 v127, v127
    v_exp_f32 v128, v128
    v_exp_f32 v129, v129
    v_exp_f32 v130, v130
    v_exp_f32 v131, v131
    v_exp_f32 v132, v132
    v_exp_f32 v133, v133
    v_exp_f32 v134, v134
    v_exp_f32 v135, v135
    v_pk_add_f32 v[120:121], v[120:121], 1.0 op_sel_hi:[1,0]
    v_pk_add_f32 v[122:123], v[122:123], 1.0 op_sel_hi:[1,0]
    v_pk_add_f32 v[124:125], v[124:125], 1.0 op_sel_hi:[1,0]
    v_pk_add_f32 v[126:127], v[126:127], 1.0 op_sel_hi:[1,0]
    v_pk_add_f32 v[128:129], v[128:129], 1.0 op_sel_hi:[1,0]
    v_pk_add_f32 v[130:131], v[130:131], 1.0 op_sel_hi:[1,0]
    v_pk_add_f32 v[132:133], v[132:133], 1.0 op_sel_hi:[1,0]
    v_pk_add_f32 v[134:135], v[134:135], 1.0 op_sel_hi:[1,0]
    v_rcp_f32 v120, v120
    v_rcp_f32 v121, v121
    v_rcp_f32 v122, v122
    v_rcp_f32 v123, v123
    v_rcp_f32 v124, v124
    v_mfma_f32_32x32x16_bf16 v[104:119], v[152:155], a[80:83], 0
    s_waitcnt vmcnt(0)
    ds_read_b128 v[24:27], v4 offset:0
    ds_read_b128 v[28:31], v4 offset:32
    ds_read_b128 v[32:35], v4 offset:64
    ds_read_b128 v[36:39], v4 offset:96
    v_rcp_f32 v125, v125
    v_rcp_f32 v126, v126
    v_mfma_f32_16x16x32_bf16 v[160:163], a[64:67], v[44:47], v[2:5]
    buffer_load_dwordx4 v168, s[24:27], 0 offen offset:0 nt lds
    buffer_load_dwordx4 v169, s[28:31], 0 offen offset:1056 nt lds
    buffer_load_dwordx4 v170, s[40:43], 0 offen offset:2112 nt lds
    buffer_load_dwordx4 v171, s[44:47], 0 offen offset:3168 nt lds
    v_mfma_f32_16x16x32_bf16 v[160:163], a[68:71], v[52:55], v[160:163]
    s_waitcnt lgkmcnt(3)
    v_rcp_f32 v127, v127
    v_mfma_f32_32x32x16_bf16 v[104:119], a[0:3], v[24:27], v[104:119]
    s_waitcnt lgkmcnt(2)
    v_rcp_f32 v128, v128
    v_cvt_pk_bf16_f32 v60, v120, v121
    v_cvt_pk_bf16_f32 v61, v122, v123
    v_cvt_pk_bf16_f32 v62, v124, v125
    v_cvt_pk_bf16_f32 v63, v126, v127
    v_mfma_f32_32x32x16_bf16 v[104:119], a[4:7], v[28:31], v[104:119]
    s_waitcnt lgkmcnt(0)
    v_rcp_f32 v129, v129
    v_rcp_f32 v130, v130
    v_rcp_f32 v131, v131
    v_mfma_f32_16x16x32_bf16 v[160:163], a[72:75], v[60:63], v[160:163]
    v_rcp_f32 v132, v132
    v_mfma_f32_32x32x16_bf16 v[104:119], a[8:11], v[32:35], v[104:119]
    v_rcp_f32 v133, v133
    v_rcp_f32 v134, v134
    v_rcp_f32 v135, v135
    v_mfma_f32_32x32x16_bf16 v[104:119], a[12:15], v[36:39], v[104:119]
    v_cvt_pk_bf16_f32 v68, v128, v129
    v_cvt_pk_bf16_f32 v69, v130, v131
    v_cvt_pk_bf16_f32 v70, v132, v133
    v_cvt_pk_bf16_f32 v71, v134, v135
    v_and_b32_e64 v15, s79, v13
    v_lshl_add_u32 v16, v15, 2, v8
    v_mfma_f32_16x16x32_bf16 v[160:163], a[76:79], v[68:71], v[160:163]
    v_mad_u32_u24 v23, v15, s37, v11
    v_and_or_b32 v164, v164, s22, v3
    v_and_or_b32 v165, v165, s22, v3
    v_and_or_b32 v166, v166, s22, v3
    v_and_or_b32 v167, v167, s22, v3
    s_branch L_p6
L_rare:
    s_barrier
    s_barrier
    s_bfe_u32 s50, s75, 0x20004
    s_mul_i32 s50, s50, 4224
    s_add_u32 s50, s50, s34
    v_and_b32 v19, 63, v0
    v_lshl_add_u32 v19, v19, 4, s50
    v_add_u32 v20, s39, v4
    v_add_u32 v21, s49, v6
    v_add_u32 v22, s49, v7
    v_mov_b32_e64 v17, v9
    v_mad_u32_u24 v23, v14, s37, v11
    ds_read_b128 v[72:75], v23 offset:4224
    ds_read_b128 v[76:79], v23 offset:4352
    ds_read_b128 v[80:83], v23 offset:4256
    ds_read_b128 v[84:87], v23 offset:4384
    ds_read_b128 v[88:91], v23 offset:4288
    ds_read_b128 v[92:95], v23 offset:4416
    ds_read_b128 v[96:99], v23 offset:4320
    ds_read_b128 v[100:103], v23 offset:4448
    ds_write_b128 v19, v[136:139] offset:0
    ds_write_b128 v19, v[136:139] offset:1056
    ds_write_b128 v19, v[136:139] offset:2112
    ds_write_b128 v19, v[136:139] offset:3168
    ds_read_b32 v13, v21 offset:128
    ds_read_b128 v[164:167], v22 offset:256
    ds_read_b128 v[168:171], v22 offset:256
    s_waitcnt vmcnt(4)
    ds_read_b128 v[24:27], v20 offset:0
    ds_read_b128 v[28:31], v20 offset:32
    ds_read_b128 v[32:35], v20 offset:64
    ds_read_b128 v[36:39], v20 offset:96
    s_waitcnt lgkmcnt(0)
    v_and_b32_e64 v15, s79, v13
    v_lshl_add_u32 v16, v15, 2, v8
    v_mad_u32_u24 v23, v15, s37, v11
    v_and_or_b32 v164, v164, s22, v3
    v_and_or_b32 v165, v165, s22, v3
    v_and_or_b32 v166, v166, s22, v3
    v_and_or_b32 v167, v167, s22, v3
    v_and_or_b32 v168, v168, s22, v3
    v_and_or_b32 v169, v169, s22, v3
    v_and_or_b32 v170, v170, s22, v3
    v_and_or_b32 v171, v171, s22, v3
    v_mfma_f32_32x32x16_bf16 v[104:119], a[0:3], v[24:27], v[104:119]
    v_mfma_f32_32x32x16_bf16 v[104:119], a[4:7], v[28:31], v[104:119]
    v_mfma_f32_32x32x16_bf16 v[104:119], a[8:11], v[32:35], v[104:119]
    v_mfma_f32_32x32x16_bf16 v[104:119], a[12:15], v[36:39], v[104:119]
    s_bitcmp0_b32 s23, 0
    s_cbranch_scc1 L_disp
    v_swap_b32 v12, v13
    v_swap_b32 v14, v15
L_disp:
    s_cmp_eq_u32 s23, 3
    s_cbranch_scc1 L_p3
    s_cmp_eq_u32 s23, 6
    s_cbranch_scc1 L_p6
    s_cmp_eq_u32 s23, 7
    s_cbranch_scc1 L_p7
    s_cmp_eq_u32 s23, 8
    s_cbranch_scc1 L_p8
    s_cmp_eq_u32 s23, 9
    s_cbranch_scc1 L_p9
    s_cmp_eq_u32 s23, 2
    s_cbranch_scc1 L_p2
    s_cmp_eq_u32 s23, 1
    s_cbranch_scc1 L_p1
L_p0:
    v_dot2_f32_bf16 v40, v24, v72, 0
    v_dot2_f32_bf16 v41, v24, v76, 0
    v_dot2_f32_bf16 v42, v25, v73, 0
    v_dot2_f32_bf16 v43, v25, v77, 0
    v_dot2_f32_bf16 v44, v26, v74, 0
    v_dot2_f32_bf16 v45, v26, v78, 0
    v_dot2_f32_bf16 v46, v27, v75, 0
    v_dot2_f32_bf16 v47, v27, v79, 0
    v_mul_f32_e64 v19, v160, v18
    v_dot2_f32_bf16 v48, v28, v80, 0
    v_dot2_f32_bf16 v49, v28, v84, 0
    v_dot2_f32_bf16 v50, v29, v81, 0
    v_dot2_f32_bf16 v51, v29, v85, 0
    v_cvt_pk_bf16_f32 v19, v19, v19
    v_dot2_f32_bf16 v52, v30, v82, 0
    v_dot2_f32_bf16 v53, v30, v86, 0
    v_dot2_f32_bf16 v54, v31, v83, 0
    v_dot2_f32_bf16 v55, v31, v87, 0
    v_dot2_f32_bf16 v56, v32, v88, 0
    v_dot2_f32_bf16 v57, v32, v92, 0
    v_dot2_f32_bf16 v58, v33, v89, 0
    v_dot2_f32_bf16 v59, v33, v93, 0
    v_cvt_pk_bf16_f32 v40, v40, v41
    v_cvt_pk_bf16_f32 v41, v42, v43
    v_cvt_pk_bf16_f32 v42, v44, v45
    v_cvt_pk_bf16_f32 v43, v46, v47
    v_dot2_f32_bf16 v60, v34, v90, 0
    v_dot2_f32_bf16 v61, v34, v94, 0
    v_dot2_f32_bf16 v62, v35, v91, 0
    v_dot2_f32_bf16 v63, v35, v95, 0
    v_dot2_f32_bf16 v64, v36, v96, 0
    v_dot2_f32_bf16 v65, v36, v100, 0
    v_dot2_f32_bf16 v66, v37, v97, 0
    v_dot2_f32_bf16 v67, v37, v101, 0
    v_dot2_f32_bf16 v68, v38, v98, 0
    v_dot2_f32_bf16 v69, v38, v102, 0
    v_dot2_f32_bf16 v70, v39, v99, 0
    v_dot2_f32_bf16 v71, v39, v103, 0
    v_mfma_f32_32x32x16_bf16 v[104:119], a[32:35], v[40:43], v[104:119]
    v_cvt_pk_bf16_f32 v48, v48, v49
    v_cvt_pk_bf16_f32 v49, v50, v51
    v_cvt_pk_bf16_f32 v50, v52, v53
    v_cvt_pk_bf16_f32 v51, v54, v55
    v_cvt_pk_bf16_f32 v56, v56, v57
    v_cvt_pk_bf16_f32 v57, v58, v59
    v_mfma_f32_32x32x16_bf16 v[104:119], a[36:39], v[48:51], v[104:119]
    v_cvt_pk_bf16_f32 v58, v60, v61
    v_cvt_pk_bf16_f32 v59, v62, v63
    v_cvt_pk_bf16_f32 v64, v64, v65
    v_cvt_pk_bf16_f32 v65, v66, v67
    v_cvt_pk_bf16_f32 v66, v68, v69
    v_cvt_pk_bf16_f32 v67, v70, v71
    v_mfma_f32_32x32x16_bf16 v[104:119], a[40:43], v[56:59], v[104:119]
    ds_read_b64_tr_b16 v[72:73], v5 offset:8448
    ds_read_b64_tr_b16 v[74:75], v5 offset:8960
    ds_write_b16 v17, v19 offset:8848
    v_lshl_add_u32 v17, v14, 2, v9
    v_and_b32 v18, s36, v12
    v_mfma_f32_32x32x16_bf16 v[104:119], a[44:47], v[64:67], v[104:119]
    s_nop 0
    ds_read_b64_tr_b16 v[76:77], v5 offset:8480
    ds_read_b64_tr_b16 v[78:79], v5 offset:8992
    ds_read_b64_tr_b16 v[80:81], v5 offset:8512
    ds_read_b64_tr_b16 v[82:83], v5 offset:9024
    ds_read_b64_tr_b16 v[84:85], v5 offset:8544
    ds_read_b64_tr_b16 v[86:87], v5 offset:9056
    v_mfma_f32_32x32x16_bf16 v[120:135], v[156:159], a[80:83], 0
    ds_read_b128 v[88:91], v10 offset:8848
    ds_read_b32 v12, v6 offset:256
    ds_read_b128 v[168:171], v7 offset:384
    ds_read_b128 a[80:83], v16
    v_exp_f32 v104, v104
    v_mfma_f32_32x32x16_bf16 v[120:135], a[16:19], v[24:27], v[120:135]
    v_exp_f32 v105, v105
    v_exp_f32 v106, v106
    v_exp_f32 v107, v107
    v_mfma_f32_32x32x16_bf16 v[120:135], a[20:23], v[28:31], v[120:135]
    v_exp_f32 v108, v108
    v_exp_f32 v109, v109
    v_exp_f32 v110, v110
    v_mfma_f32_32x32x16_bf16 v[120:135], a[24:27], v[32:35], v[120:135]
    v_exp_f32 v111, v111
    v_exp_f32 v112, v112
    v_exp_f32 v113, v113
    v_mfma_f32_32x32x16_bf16 v[120:135], a[28:31], v[36:39], v[120:135]
    v_exp_f32 v114, v114
    v_exp_f32 v115, v115
    v_exp_f32 v116, v116
    v_exp_f32 v117, v117
    v_exp_f32 v118, v118
    v_exp_f32 v119, v119
    v_pk_add_f32 v[104:105], v[104:105], 1.0 op_sel_hi:[1,0]
    v_pk_add_f32 v[106:107], v[106:107], 1.0 op_sel_hi:[1,0]
    v_pk_add_f32 v[108:109], v[108:109], 1.0 op_sel_hi:[1,0]
    v_pk_add_f32 v[110:111], v[110:111], 1.0 op_sel_hi:[1,0]
    v_pk_add_f32 v[112:113], v[112:113], 1.0 op_sel_hi:[1,0]
    v_pk_add_f32 v[114:115], v[114:115], 1.0 op_sel_hi:[1,0]
    v_pk_add_f32 v[116:117], v[116:117], 1.0 op_sel_hi:[1,0]
    v_pk_add_f32 v[118:119], v[118:119], 1.0 op_sel_hi:[1,0]
    v_mfma_f32_32x32x16_bf16 v[120:135], a[48:51], v[40:43], v[120:135]
    s_waitcnt lgkmcnt(0)
    v_rcp_f32 v104, v104
    v_rcp_f32 v105, v105
    v_rcp_f32 v106, v106
    v_mfma_f32_32x32x16_bf16 v[120:135], a[52:55], v[48:51], v[120:135]
    s_add_u32 m0, s34, 8448
    v_rcp_f32 v107, v107
    v_rcp_f32 v108, v108
    v_rcp_f32 v109, v109
    v_mfma_f32_32x32x16_bf16 v[120:135], a[56:59], v[56:59], v[120:135]
    v_rcp_f32 v110, v110
    v_rcp_f32 v111, v111
    v_rcp_f32 v112, v112
    v_mfma_f32_32x32x16_bf16 v[120:135], a[60:63], v[64:67], v[120:135]
    v_rcp_f32 v113, v113
    v_rcp_f32 v114, v114
    v_rcp_f32 v115, v115
    v_mfma_f32_16x16x32_bf16 v[136:139], v[72:75], v[88:91], v[136:139]
    v_rcp_f32 v116, v116
    v_mfma_f32_16x16x32_bf16 v[140:143], v[76:79], v[88:91], v[140:143]
    v_rcp_f32 v117, v117
    v_mfma_f32_16x16x32_bf16 v[144:147], v[80:83], v[88:91], v[144:147]
    v_rcp_f32 v118, v118
    v_mfma_f32_16x16x32_bf16 v[148:151], v[84:87], v[88:91], v[148:151]
    ds_read_b128 v[72:75], v23 offset:4224
    ds_read_b128 v[76:79], v23 offset:4352
    ds_read_b128 v[80:83], v23 offset:4256
    ds_read_b128 v[84:87], v23 offset:4384
    ds_read_b128 v[88:91], v23 offset:4288
    ds_read_b128 v[92:95], v23 offset:4416
    ds_read_b128 v[96:99], v23 offset:4320
    ds_read_b128 v[100:103], v23 offset:4448
    v_rcp_f32_e64 v119, v119
    v_cvt_pk_bf16_f32 v44, v104, v105
    v_cvt_pk_bf16_f32 v45, v106, v107
    v_cvt_pk_bf16_f32 v46, v108, v109
    v_cvt_pk_bf16_f32 v47, v110, v111
    v_cvt_pk_bf16_f32 v52, v112, v113
    v_cvt_pk_bf16_f32 v53, v114, v115
    v_cvt_pk_bf16_f32 v54, v116, v117
    v_cvt_pk_bf16_f32 v55, v118, v119
    v_exp_f32 v120, v120
    v_exp_f32 v121, v121
    v_exp_f32 v122, v122
    v_exp_f32 v123, v123
    v_exp_f32 v124, v124
    v_exp_f32 v125, v125
    v_exp_f32 v126, v126
    v_exp_f32 v127, v127
    v_exp_f32 v128, v128
    v_exp_f32 v129, v129
    v_exp_f32 v130, v130
    v_exp_f32 v131, v131
    v_exp_f32 v132, v132
    v_exp_f32 v133, v133
    v_exp_f32 v134, v134
    v_exp_f32 v135, v135
    v_pk_add_f32 v[120:121], v[120:121], 1.0 op_sel_hi:[1,0]
    v_pk_add_f32 v[122:123], v[122:123], 1.0 op_sel_hi:[1,0]
    v_pk_add_f32 v[124:125], v[124:125], 1.0 op_sel_hi:[1,0]
    v_pk_add_f32 v[126:127], v[126:127], 1.0 op_sel_hi:[1,0]
    v_pk_add_f32 v[128:129], v[128:129], 1.0 op_sel_hi:[1,0]
    v_pk_add_f32 v[130:131], v[130:131], 1.0 op_sel_hi:[1,0]
    v_pk_add_f32 v[132:133], v[132:133], 1.0 op_sel_hi:[1,0]
    v_pk_add_f32 v[134:135], v[134:135], 1.0 op_sel_hi:[1,0]
    v_rcp_f32 v120, v120
    v_rcp_f32 v121, v121
    v_rcp_f32 v122, v122
    v_rcp_f32 v123, v123
    v_rcp_f32 v124, v124
    v_mfma_f32_32x32x16_bf16 v[104:119], v[152:155], a[80:83], 0
    s_waitcnt vmcnt(0)
    ds_read_b128 v[24:27], v4 offset:4224
    ds_read_b128 v[28:31], v4 offset:4256
    ds_read_b128 v[32:35], v4 offset:4288
    ds_read_b128 v[36:39], v4 offset:4320
    v_rcp_f32 v125, v125
    v_rcp_f32 v126, v126
    v_mfma_f32_16x16x32_bf16 v[160:163], a[64:67], v[44:47], v[2:5]
    buffer_load_dwordx4 v164, s[24:27], 0 offen offset:0 nt lds
    buffer_load_dwordx4 v165, s[28:31], 0 offen offset:1056 nt lds
    buffer_load_dwordx4 v166, s[40:43], 0 offen offset:2112 nt lds
    buffer_load_dwordx4 v167, s[44:47], 0 offen offset:3168 nt lds
    v_mfma_f32_16x16x32_bf16 v[160:163], a[68:71], v[52:55], v[160:163]
    s_waitcnt lgkmcnt(3)
    v_rcp_f32 v127, v127
    v_mfma_f32_32x32x16_bf16 v[104:119], a[0:3], v[24:27], v[104:119]
    s_waitcnt lgkmcnt(2)
    v_rcp_f32 v128, v128
    v_cvt_pk_bf16_f32 v60, v120, v121
    v_cvt_pk_bf16_f32 v61, v122, v123
    v_cvt_pk_bf16_f32 v62, v124, v125
    v_cvt_pk_bf16_f32 v63, v126, v127
    v_mfma_f32_32x32x16_bf16 v[104:119], a[4:7], v[28:31], v[104:119]
    s_waitcnt lgkmcnt(0)
    v_rcp_f32 v129, v129
    v_rcp_f32 v130, v130
    v_rcp_f32 v131, v131
    v_mfma_f32_16x16x32_bf16 v[160:163], a[72:75], v[60:63], v[160:163]
    v_rcp_f32 v132, v132
    v_mfma_f32_32x32x16_bf16 v[104:119], a[8:11], v[32:35], v[104:119]
    v_rcp_f32 v133, v133
    v_rcp_f32 v134, v134
    v_rcp_f32 v135, v135
    v_mfma_f32_32x32x16_bf16 v[104:119], a[12:15], v[36:39], v[104:119]
    v_cvt_pk_bf16_f32 v68, v128, v129
    v_cvt_pk_bf16_f32 v69, v130, v131
    v_cvt_pk_bf16_f32 v70, v132, v133
    v_cvt_pk_bf16_f32 v71, v134, v135
    v_and_b32_e64 v14, s79, v12
    v_lshl_add_u32 v16, v14, 2, v8
    v_mfma_f32_16x16x32_bf16 v[160:163], a[76:79], v[68:71], v[160:163]
    v_mad_u32_u24 v23, v14, s37, v11
    v_and_or_b32 v168, v168, s22, v3
    v_and_or_b32 v169, v169, s22, v3
    v_and_or_b32 v170, v170, s22, v3
    v_and_or_b32 v171, v171, s22, v3
L_p1:
    v_dot2_f32_bf16 v40, v24, v72, 0
    v_dot2_f32_bf16 v41, v24, v76, 0
    v_dot2_f32_bf16 v42, v25, v73, 0
    v_dot2_f32_bf16 v43, v25, v77, 0
    v_dot2_f32_bf16 v44, v26, v74, 0
    v_dot2_f32_bf16 v45, v26, v78, 0
    v_dot2_f32_bf16 v46, v27, v75, 0
    v_dot2_f32_bf16 v47, v27, v79, 0
    v_mul_f32_e64 v19, v160, v18
    v_dot2_f32_bf16 v48, v28, v80, 0
    v_dot2_f32_bf16 v49, v28, v84, 0
    v_dot2_f32_bf16 v50, v29, v81, 0
    v_dot2_f32_bf16 v51, v29, v85, 0
    v_cvt_pk_bf16_f32 v19, v19, v19
    v_dot2_f32_bf16 v52, v30, v82, 0
    v_dot2_f32_bf16 v53, v30, v86, 0
    v_dot2_f32_bf16 v54, v31, v83, 0
    v_dot2_f32_bf16 v55, v31, v87, 0
    v_dot2_f32_bf16 v56, v32, v88, 0
    v_dot2_f32_bf16 v57, v32, v92, 0
    v_dot2_f32_bf16 v58, v33, v89, 0
    v_dot2_f32_bf16 v59, v33, v93, 0
    v_cvt_pk_bf16_f32 v40, v40, v41
    v_cvt_pk_bf16_f32 v41, v42, v43
    v_cvt_pk_bf16_f32 v42, v44, v45
    v_cvt_pk_bf16_f32 v43, v46, v47
    v_dot2_f32_bf16 v60, v34, v90, 0
    v_dot2_f32_bf16 v61, v34, v94, 0
    v_dot2_f32_bf16 v62, v35, v91, 0
    v_dot2_f32_bf16 v63, v35, v95, 0
    v_dot2_f32_bf16 v64, v36, v96, 0
    v_dot2_f32_bf16 v65, v36, v100, 0
    v_dot2_f32_bf16 v66, v37, v97, 0
    v_dot2_f32_bf16 v67, v37, v101, 0
    v_dot2_f32_bf16 v68, v38, v98, 0
    v_dot2_f32_bf16 v69, v38, v102, 0
    v_dot2_f32_bf16 v70, v39, v99, 0
    v_dot2_f32_bf16 v71, v39, v103, 0
    v_mfma_f32_32x32x16_bf16 v[104:119], a[32:35], v[40:43], v[104:119]
    v_cvt_pk_bf16_f32 v48, v48, v49
    v_cvt_pk_bf16_f32 v49, v50, v51
    v_cvt_pk_bf16_f32 v50, v52, v53
    v_cvt_pk_bf16_f32 v51, v54, v55
    v_cvt_pk_bf16_f32 v56, v56, v57
    v_cvt_pk_bf16_f32 v57, v58, v59
    v_mfma_f32_32x32x16_bf16 v[104:119], a[36:39], v[48:51], v[104:119]
    v_cvt_pk_bf16_f32 v58, v60, v61
    v_cvt_pk_bf16_f32 v59, v62, v63
    v_cvt_pk_bf16_f32 v64, v64, v65
    v_cvt_pk_bf16_f32 v65, v66, v67
    v_cvt_pk_bf16_f32 v66, v68, v69
    v_cvt_pk_bf16_f32 v67, v70, v71
    v_mfma_f32_32x32x16_bf16 v[104:119], a[40:43], v[56:59], v[104:119]
    ds_read_b64_tr_b16 v[72:73], v5 offset:0
    ds_read_b64_tr_b16 v[74:75], v5 offset:512
    ds_write_b16 v17, v19 offset:9936
    v_lshl_add_u32 v17, v15, 2, v9
    v_and_b32 v18, s36, v13
    v_mfma_f32_32x32x16_bf16 v[104:119], a[44:47], v[64:67], v[104:119]
    s_nop 0
    ds_read_b64_tr_b16 v[76:77], v5 offset:32
    ds_read_b64_tr_b16 v[78:79], v5 offset:544
    ds_read_b64_tr_b16 v[80:81], v5 offset:64
    ds_read_b64_tr_b16 v[82:83], v5 offset:576
    ds_read_b64_tr_b16 v[84:85], v5 offset:96
    ds_read_b64_tr_b16 v[86:87], v5 offset:608
    v_mfma_f32_32x32x16_bf16 v[120:135], v[156:159], a[80:83], 0
    ds_read_b128 v[88:91], v10 offset:9936
    ds_read_b32 v13, v6 offset:384
    ds_read_b128 v[164:167], v7 offset:512
    ds_read_b128 a[80:83], v16
    v_exp_f32 v104, v104
    v_mfma_f32_32x32x16_bf16 v[120:135], a[16:19], v[24:27], v[120:135]
    v_exp_f32 v105, v105
    v_exp_f32 v106, v106
    v_exp_f32 v107, v107
    v_mfma_f32_32x32x16_bf16 v[120:135], a[20:23], v[28:31], v[120:135]
    v_exp_f32 v108, v108
    v_exp_f32 v109, v109
    v_exp_f32 v110, v110
    v_mfma_f32_32x32x16_bf16 v[120:135], a[24:27], v[32:35], v[120:135]
    v_exp_f32 v111, v111
    v_exp_f32 v112, v112
    v_exp_f32 v113, v113
    v_mfma_f32_32x32x16_bf16 v[120:135], a[28:31], v[36:39], v[120:135]
    v_exp_f32 v114, v114
    v_exp_f32 v115, v115
    v_exp_f32 v116, v116
    v_exp_f32 v117, v117
    v_exp_f32 v118, v118
    v_exp_f32 v119, v119
    v_pk_add_f32 v[104:105], v[104:105], 1.0 op_sel_hi:[1,0]
    v_pk_add_f32 v[106:107], v[106:107], 1.0 op_sel_hi:[1,0]
    v_pk_add_f32 v[108:109], v[108:109], 1.0 op_sel_hi:[1,0]
    v_pk_add_f32 v[110:111], v[110:111], 1.0 op_sel_hi:[1,0]
    v_pk_add_f32 v[112:113], v[112:113], 1.0 op_sel_hi:[1,0]
    v_pk_add_f32 v[114:115], v[114:115], 1.0 op_sel_hi:[1,0]
    v_pk_add_f32 v[116:117], v[116:117], 1.0 op_sel_hi:[1,0]
    v_pk_add_f32 v[118:119], v[118:119], 1.0 op_sel_hi:[1,0]
    v_mfma_f32_32x32x16_bf16 v[120:135], a[48:51], v[40:43], v[120:135]
    s_waitcnt lgkmcnt(0)
    v_rcp_f32 v104, v104
    v_rcp_f32 v105, v105
    v_rcp_f32 v106, v106
    v_mfma_f32_32x32x16_bf16 v[120:135], a[52:55], v[48:51], v[120:135]
    s_add_u32 m0, s34, 0
    v_rcp_f32 v107, v107
    v_rcp_f32 v108, v108
    v_rcp_f32 v109, v109
    v_mfma_f32_32x32x16_bf16 v[120:135], a[56:59], v[56:59], v[120:135]
    v_rcp_f32 v110, v110
    v_rcp_f32 v111, v111
    v_rcp_f32 v112, v112
    v_mfma_f32_32x32x16_bf16 v[120:135], a[60:63], v[64:67], v[120:135]
    v_rcp_f32 v113, v113
    v_rcp_f32 v114, v114
    v_rcp_f32 v115, v115
    v_mfma_f32_16x16x32_bf16 v[136:139], v[72:75], v[88:91], v[136:139]
    v_rcp_f32 v116, v116
    v_mfma_f32_16x16x32_bf16 v[140:143], v[76:79], v[88:91], v[140:143]
    v_rcp_f32 v117, v117
    v_mfma_f32_16x16x32_bf16 v[144:147], v[80:83], v[88:91], v[144:147]
    v_rcp_f32_e64 v118, v118
    v_mfma_f32_16x16x32_bf16 v[148:151], v[84:87], v[88:91], v[148:151]
    ds_read_b128 v[72:75], v23 offset:4224
    ds_read_b128 v[76:79], v23 offset:4352
    ds_read_b128 v[80:83], v23 offset:4256
    ds_read_b128 v[84:87], v23 offset:4384
    ds_read_b128 v[88:91], v23 offset:4288
    ds_read_b128 v[92:95], v23 offset:4416
    ds_read_b128 v[96:99], v23 offset:4320
    ds_read_b128 v[100:103], v23 offset:4448
    v_rcp_f32_e64 v119, v119
    v_cvt_pk_bf16_f32 v44, v104, v105
    v_cvt_pk_bf16_f32 v45, v106, v107
    v_cvt_pk_bf16_f32 v46, v108, v109
    v_cvt_pk_bf16_f32 v47, v110, v111
    v_cvt_pk_bf16_f32 v52, v112, v113
    v_cvt_pk_bf16_f32 v53, v114, v115
    v_cvt_pk_bf16_f32 v54, v116, v117
    v_cvt_pk_bf16_f32 v55, v118, v119
    v_exp_f32 v120, v120
    v_exp_f32 v121, v121
    v_exp_f32 v122, v122
    v_exp_f32 v123, v123
    v_exp_f32 v124, v124
    v_exp_f32 v125, v125
    v_exp_f32 v126, v126
    v_exp_f32 v127, v127
    v_exp_f32 v128, v128
    v_exp_f32 v129, v129
    v_exp_f32 v130, v130
    v_exp_f32 v131, v131
    v_exp_f32 v132, v132
    v_exp_f32 v133, v133
    v_exp_f32 v134, v134
    v_exp_f32 v135, v135
    v_pk_add_f32 v[120:121], v[120:121], 1.0 op_sel_hi:[1,0]
    v_pk_add_f32 v[122:123], v[122:123], 1.0 op_sel_hi:[1,0]
    v_pk_add_f32 v[124:125], v[124:125], 1.0 op_sel_hi:[1,0]
    v_pk_add_f32 v[126:127], v[126:127], 1.0 op_sel_hi:[1,0]
    v_pk_add_f32 v[128:129], v[128:129], 1.0 op_sel_hi:[1,0]
    v_pk_add_f32 v[130:131], v[130:131], 1.0 op_sel_hi:[1,0]
    v_pk_add_f32 v[132:133], v[132:133], 1.0 op_sel_hi:[1,0]
    v_pk_add_f32 v[134:135], v[134:135], 1.0 op_sel_hi:[1,0]
    v_rcp_f32 v120, v120
    v_rcp_f32 v121, v121
    v_rcp_f32 v122, v122
    v_rcp_f32 v123, v123
    v_rcp_f32 v124, v124
    v_mfma_f32_32x32x16_bf16 v[104:119], v[152:155], a[80:83], 0
    s_waitcnt vmcnt(0)
    ds_read_b128 v[24:27], v4 offset:8448
    ds_read_b128 v[28:31], v4 offset:8480
    ds_read_b128 v[32:35], v4 offset:8512
    ds_read_b128 v[36:39], v4 offset:8544
    v_rcp_f32 v125, v125
    v_rcp_f32 v126, v126
    v_mfma_f32_16x16x32_bf16 v[160:163], a[64:67], v[44:47], v[2:5]
    buffer_load_dwordx4 v168, s[24:27], 0 offen offset:0 nt lds
    buffer_load_dwordx4 v169, s[28:31], 0 offen offset:1056 nt lds
    buffer_load_dwordx4 v170, s[40:43], 0 offen offset:2112 nt lds
    buffer_load_dwordx4 v171, s[44:47], 0 offen offset:3168 nt lds
    v_mfma_f32_16x16x32_bf16 v[160:163], a[68:71], v[52:55], v[160:163]
    s_waitcnt lgkmcnt(3)
    v_rcp_f32 v127, v127
    v_mfma_f32_32x32x16_bf16 v[104:119], a[0:3], v[24:27], v[104:119]
    s_waitcnt lgkmcnt(2)
    v_rcp_f32 v128, v128
    v_cvt_pk_bf16_f32 v60, v120, v121
    v_cvt_pk_bf16_f32 v61, v122, v123
    v_cvt_pk_bf16_f32 v62, v124, v125
    v_cvt_pk_bf16_f32 v63, v126, v127
    v_mfma_f32_32x32x16_bf16 v[104:119], a[4:7], v[28:31], v[104:119]
    s_waitcnt lgkmcnt(0)
    v_rcp_f32 v129, v129
    v_rcp_f32 v130, v130
    v_rcp_f32 v131, v131
    v_mfma_f32_16x16x32_bf16 v[160:163], a[72:75], v[60:63], v[160:163]
    v_rcp_f32 v132, v132
    v_mfma_f32_32x32x16_bf16 v[104:119], a[8:11], v[32:35], v[104:119]
    v_rcp_f32 v133, v133
    v_rcp_f32 v134, v134
    v_rcp_f32 v135, v135
    v_mfma_f32_32x32x16_bf16 v[104:119], a[12:15], v[36:39], v[104:119]
    v_cvt_pk_bf16_f32 v68, v128, v129
    v_cvt_pk_bf16_f32 v69, v130, v131
    v_cvt_pk_bf16_f32 v70, v132, v133
    v_cvt_pk_bf16_f32 v71, v134, v135
    v_and_b32_e64 v15, s79, v13
    v_lshl_add_u32 v16, v15, 2, v8
    v_mfma_f32_16x16x32_bf16 v[160:163], a[76:79], v[68:71], v[160:163]
    v_mad_u32_u24 v23, v15, s37, v11
    v_and_or_b32 v164, v164, s22, v3
    v_and_or_b32 v165, v165, s22, v3
    v_and_or_b32 v166, v166, s22, v3
    v_and_or_b32 v167, v167, s22, v3
L_p2:
    v_dot2_f32_bf16 v40, v24, v72, 0
    v_dot2_f32_bf16 v41, v24, v76, 0
    v_dot2_f32_bf16 v42, v25, v73, 0
    v_dot2_f32_bf16 v43, v25, v77, 0
    v_dot2_f32_bf16 v44, v26, v74, 0
    v_dot2_f32_bf16 v45, v26, v78, 0
    v_dot2_f32_bf16 v46, v27, v75, 0
    v_dot2_f32_bf16 v47, v27, v79, 0
    v_mul_f32_e64 v19, v160, v18
    v_dot2_f32_bf16 v48, v28, v80, 0
    v_dot2_f32_bf16 v49, v28, v84, 0
    v_dot2_f32_bf16 v50, v29, v81, 0
    v_dot2_f32_bf16 v51, v29, v85, 0
    v_cvt_pk_bf16_f32 v19, v19, v19
    v_dot2_f32_bf16 v52, v30, v82, 0
    v_dot2_f32_bf16 v53, v30, v86, 0
    v_dot2_f32_bf16 v54, v31, v83, 0
    v_dot2_f32_bf16 v55, v31, v87, 0
    v_dot2_f32_bf16 v56, v32, v88, 0
    v_dot2_f32_bf16 v57, v32, v92, 0
    v_dot2_f32_bf16 v58, v33, v89, 0
    v_dot2_f32_bf16 v59, v33, v93, 0
    v_cvt_pk_bf16_f32 v40, v40, v41
    v_cvt_pk_bf16_f32 v41, v42, v43
    v_cvt_pk_bf16_f32 v42, v44, v45
    v_cvt_pk_bf16_f32 v43, v46, v47
    v_dot2_f32_bf16 v60, v34, v90, 0
    v_dot2_f32_bf16 v61, v34, v94, 0
    v_dot2_f32_bf16 v62, v35, v91, 0
    v_dot2_f32_bf16 v63, v35, v95, 0
    v_dot2_f32_bf16 v64, v36, v96, 0
    v_dot2_f32_bf16 v65, v36, v100, 0
    v_dot2_f32_bf16 v66, v37, v97, 0
    v_dot2_f32_bf16 v67, v37, v101, 0
    v_dot2_f32_bf16 v68, v38, v98, 0
    v_dot2_f32_bf16 v69, v38, v102, 0
    v_dot2_f32_bf16 v70, v39, v99, 0
    v_dot2_f32_bf16 v71, v39, v103, 0
    v_mfma_f32_32x32x16_bf16 v[104:119], a[32:35], v[40:43], v[104:119]
    v_cvt_pk_bf16_f32 v48, v48, v49
    v_cvt_pk_bf16_f32 v49, v50, v51
    v_cvt_pk_bf16_f32 v50, v52, v53
    v_cvt_pk_bf16_f32 v51, v54, v55
    v_cvt_pk_bf16_f32 v56, v56, v57
    v_cvt_pk_bf16_f32 v57, v58, v59
    v_mfma_f32_32x32x16_bf16 v[104:119], a[36:39], v[48:51], v[104:119]
    v_cvt_pk_bf16_f32 v58, v60, v61
    v_cvt_pk_bf16_f32 v59, v62, v63
    v_cvt_pk_bf16_f32 v64, v64, v65
    v_cvt_pk_bf16_f32 v65, v66, v67
    v_cvt_pk_bf16_f32 v66, v68, v69
    v_cvt_pk_bf16_f32 v67, v70, v71
    v_mfma_f32_32x32x16_bf16 v[104:119], a[40:43], v[56:59], v[104:119]
    ds_read_b64_tr_b16 v[72:73], v5 offset:4224
    ds_read_b64_tr_b16 v[74:75], v5 offset:4736
    ds_write_b16 v17, v19 offset:11024
    v_lshl_add_u32 v17, v14, 2, v9
    v_and_b32 v18, s36, v12
    v_mfma_f32_32x32x16_bf16 v[104:119], a[44:47], v[64:67], v[104:119]
    s_nop 0
    ds_read_b64_tr_b16 v[76:77], v5 offset:4256
    ds_read_b64_tr_b16 v[78:79], v5 offset:4768
    ds_read_b64_tr_b16 v[80:81], v5 offset:4288
    ds_read_b64_tr_b16 v[82:83], v5 offset:4800
    ds_read_b64_tr_b16 v[84:85], v5 offset:4320
    ds_read_b64_tr_b16 v[86:87], v5 offset:4832
    v_mfma_f32_32x32x16_bf16 v[120:135], v[156:159], a[80:83], 0
    ds_read_b128 v[88:91], v10 offset:11024
    ds_read_b32 v12, v6 offset:512
    ds_read_b128 v[168:171], v7 offset:640
    ds_read_b128 a[80:83], v16
    v_exp_f32 v104, v104
    v_mfma_f32_32x32x16_bf16 v[120:135], a[16:19], v[24:27], v[120:135]
    v_exp_f32 v105, v105
    v_exp_f32 v106, v106
    v_exp_f32 v107, v107
    v_mfma_f32_32x32x16_bf16 v[120:135], a[20:23], v[28:31], v[120:135]
    v_exp_f32 v108, v108
    v_exp_f32 v109, v109
    v_exp_f32 v110, v110
    v_mfma_f32_32x32x16_bf16 v[120:135], a[24:27], v[32:35], v[120:135]
    v_exp_f32 v111, v111
    v_exp_f32 v112, v112
    v_exp_f32 v113, v113
    v_mfma_f32_32x32x16_bf16 v[120:135], a[28:31], v[36:39], v[120:135]
    v_exp_f32 v114, v114
    v_exp_f32 v115, v115
    v_exp_f32 v116, v116
    v_exp_f32 v117, v117
    v_exp_f32 v118, v118
    v_exp_f32 v119, v119
    v_pk_add_f32 v[104:105], v[104:105], 1.0 op_sel_hi:[1,0]
    v_pk_add_f32 v[106:107], v[106:107], 1.0 op_sel_hi:[1,0]
    v_pk_add_f32 v[108:109], v[108:109], 1.0 op_sel_hi:[1,0]
    v_pk_add_f32 v[110:111], v[110:111], 1.0 op_sel_hi:[1,0]
    v_pk_add_f32 v[112:113], v[112:113], 1.0 op_sel_hi:[1,0]
    v_pk_add_f32 v[114:115], v[114:115], 1.0 op_sel_hi:[1,0]
    v_pk_add_f32 v[116:117], v[116:117], 1.0 op_sel_hi:[1,0]
    v_pk_add_f32 v[118:119], v[118:119], 1.0 op_sel_hi:[1,0]
    v_mfma_f32_32x32x16_bf16 v[120:135], a[48:51], v[40:43], v[120:135]
    s_waitcnt lgkmcnt(0)
    v_rcp_f32 v104, v104
    v_rcp_f32 v105, v105
    v_rcp_f32 v106, v106
    v_mfma_f32_32x32x16_bf16 v[120:135], a[52:55], v[48:51], v[120:135]
    s_add_u32 m0, s34, 4224
    v_rcp_f32 v107, v107
    v_rcp_f32 v108, v108
    v_rcp_f32 v109, v109
    v_mfma_f32_32x32x16_bf16 v[120:135], a[56:59], v[56:59], v[120:135]
    v_rcp_f32 v110, v110
    v_rcp_f32 v111, v111
    v_rcp_f32 v112, v112
    v_mfma_f32_32x32x16_bf16 v[120:135], a[60:63], v[64:67], v[120:135]
    v_rcp_f32 v113, v113
    v_rcp_f32 v114, v114
    v_rcp_f32 v115, v115
    v_mfma_f32_16x16x32_bf16 v[136:139], v[72:75], v[88:91], v[136:139]
    v_rcp_f32 v116, v116
    v_mfma_f32_16x16x32_bf16 v[140:143], v[76:79], v[88:91], v[140:143]
    v_rcp_f32 v117, v117
    v_mfma_f32_16x16x32_bf16 v[144:147], v[80:83], v[88:91], v[144:147]
    v_rcp_f32 v118, v118
    v_mfma_f32_16x16x32_bf16 v[148:151], v[84:87], v[88:91], v[148:151]
    ds_read_b128 v[72:75], v23 offset:4224
    ds_read_b128 v[76:79], v23 offset:4352
    ds_read_b128 v[80:83], v23 offset:4256
    ds_read_b128 v[84:87], v23 offset:4384
    ds_read_b128 v[88:91], v23 offset:4288
    ds_read_b128 v[92:95], v23 offset:4416
    ds_read_b128 v[96:99], v23 offset:4320
    ds_read_b128 v[100:103], v23 offset:4448
    v_rcp_f32_e64 v119, v119
    v_cvt_pk_bf16_f32 v44, v104, v105
    v_cvt_pk_bf16_f32 v45, v106, v107
    v_cvt_pk_bf16_f32 v46, v108, v109
    v_cvt_pk_bf16_f32 v47, v110, v111
    v_cvt_pk_bf16_f32 v52, v112, v113
    v_cvt_pk_bf16_f32 v53, v114, v115
    v_cvt_pk_bf16_f32 v54, v116, v117
    v_cvt_pk_bf16_f32 v55, v118, v119
    v_exp_f32 v120, v120
    v_exp_f32 v121, v121
    v_exp_f32 v122, v122
    v_exp_f32 v123, v123
    v_exp_f32 v124, v124
    v_exp_f32 v125, v125
    v_exp_f32 v126, v126
    v_exp_f32 v127, v127
    v_exp_f32 v128, v128
    v_exp_f32 v129, v129
    v_exp_f32 v130, v130
    v_exp_f32 v131, v131
    v_exp_f32 v132, v132
    v_exp_f32 v133, v133
    v_exp_f32 v134, v134
    v_exp_f32 v135, v135
    v_pk_add_f32 v[120:121], v[120:121], 1.0 op_sel_hi:[1,0]
    v_pk_add_f32 v[122:123], v[122:123], 1.0 op_sel_hi:[1,0]
    v_pk_add_f32 v[124:125], v[124:125], 1.0 op_sel_hi:[1,0]
    v_pk_add_f32 v[126:127], v[126:127], 1.0 op_sel_hi:[1,0]
    v_pk_add_f32 v[128:129], v[128:129], 1.0 op_sel_hi:[1,0]
    v_pk_add_f32 v[130:131], v[130:131], 1.0 op_sel_hi:[1,0]
    v_pk_add_f32 v[132:133], v[132:133], 1.0 op_sel_hi:[1,0]
    v_pk_add_f32 v[134:135], v[134:135], 1.0 op_sel_hi:[1,0]
    v_rcp_f32 v120, v120
    v_rcp_f32 v121, v121
    v_rcp_f32 v122, v122
    v_rcp_f32 v123, v123
    v_rcp_f32 v124, v124
    v_mfma_f32_32x32x16_bf16 v[104:119], v[152:155], a[80:83], 0
    s_waitcnt vmcnt(0)
    ds_read_b128 v[24:27], v4 offset:0
    ds_read_b128 v[28:31], v4 offset:32
    ds_read_b128 v[32:35], v4 offset:64
    ds_read_b128 v[36:39], v4 offset:96
    v_rcp_f32 v125, v125
    v_rcp_f32 v126, v126
    v_mfma_f32_16x16x32_bf16 v[160:163], a[64:67], v[44:47], v[2:5]
    buffer_load_dwordx4 v164, s[24:27], 0 offen offset:0 nt lds
    buffer_load_dwordx4 v165, s[28:31], 0 offen offset:1056 nt lds
    buffer_load_dwordx4 v166, s[40:43], 0 offen offset:2112 nt lds
    buffer_load_dwordx4 v167, s[44:47], 0 offen offset:3168 nt lds
    v_mfma_f32_16x16x32_bf16 v[160:163], a[68:71], v[52:55], v[160:163]
    s_waitcnt lgkmcnt(3)
    v_rcp_f32 v127, v127
    v_mfma_f32_32x32x16_bf16 v[104:119], a[0:3], v[24:27], v[104:119]
    s_waitcnt lgkmcnt(2)
    v_rcp_f32 v128, v128
    v_cvt_pk_bf16_f32 v60, v120, v121
    v_cvt_pk_bf16_f32 v61, v122, v123
    v_cvt_pk_bf16_f32 v62, v124, v125
    v_cvt_pk_bf16_f32 v63, v126, v127
    v_mfma_f32_32x32x16_bf16 v[104:119], a[4:7], v[28:31], v[104:119]
    s_waitcnt lgkmcnt(0)
    v_rcp_f32 v129, v129
    v_rcp_f32 v130, v130
    v_rcp_f32 v131, v131
    v_mfma_f32_16x16x32_bf16 v[160:163], a[72:75], v[60:63], v[160:163]
    v_rcp_f32 v132, v132
    v_mfma_f32_32x32x16_bf16 v[104:119], a[8:11], v[32:35], v[104:119]
    v_rcp_f32 v133, v133
    v_rcp_f32 v134, v134
    v_rcp_f32 v135, v135
    v_mfma_f32_32x32x16_bf16 v[104:119], a[12:15], v[36:39], v[104:119]
    v_cvt_pk_bf16_f32 v68, v128, v129
    v_cvt_pk_bf16_f32 v69, v130, v131
    v_cvt_pk_bf16_f32 v70, v132, v133
    v_cvt_pk_bf16_f32 v71, v134, v135
    v_and_b32_e64 v14, s79, v12
    v_lshl_add_u32 v16, v14, 2, v8
    v_mfma_f32_16x16x32_bf16 v[160:163], a[76:79], v[68:71], v[160:163]
    v_mad_u32_u24 v23, v14, s37, v11
    v_and_or_b32 v168, v168, s22, v3
    v_and_or_b32 v169, v169, s22, v3
    v_and_or_b32 v170, v170, s22, v3
    v_and_or_b32 v171, v171, s22, v3
L_p3:
    v_dot2_f32_bf16 v40, v24, v72, 0
    v_dot2_f32_bf16 v41, v24, v76, 0
    v_dot2_f32_bf16 v42, v25, v73, 0
    v_dot2_f32_bf16 v43, v25, v77, 0
    v_dot2_f32_bf16 v44, v26, v74, 0
    v_dot2_f32_bf16 v45, v26, v78, 0
    v_dot2_f32_bf16 v46, v27, v75, 0
    v_dot2_f32_bf16 v47, v27, v79, 0
    v_mul_f32_e64 v19, v160, v18
    v_dot2_f32_bf16 v48, v28, v80, 0
    v_dot2_f32_bf16 v49, v28, v84, 0
    v_dot2_f32_bf16 v50, v29, v81, 0
    v_dot2_f32_bf16 v51, v29, v85, 0
    v_cvt_pk_bf16_f32 v19, v19, v19
    v_dot2_f32_bf16 v52, v30, v82, 0
    v_dot2_f32_bf16 v53, v30, v86, 0
    v_dot2_f32_bf16 v54, v31, v83, 0
    v_dot2_f32_bf16 v55, v31, v87, 0
    v_dot2_f32_bf16 v56, v32, v88, 0
    v_dot2_f32_bf16 v57, v32, v92, 0
    v_dot2_f32_bf16 v58, v33, v89, 0
    v_dot2_f32_bf16 v59, v33, v93, 0
    v_cvt_pk_bf16_f32 v40, v40, v41
    v_cvt_pk_bf16_f32 v41, v42, v43
    v_cvt_pk_bf16_f32 v42, v44, v45
    v_cvt_pk_bf16_f32 v43, v46, v47
    v_dot2_f32_bf16 v60, v34, v90, 0
    v_dot2_f32_bf16 v61, v34, v94, 0
    v_dot2_f32_bf16 v62, v35, v91, 0
    v_dot2_f32_bf16 v63, v35, v95, 0
    v_dot2_f32_bf16 v64, v36, v96, 0
    v_dot2_f32_bf16 v65, v36, v100, 0
    v_dot2_f32_bf16 v66, v37, v97, 0
    v_dot2_f32_bf16 v67, v37, v101, 0
    v_dot2_f32_bf16 v68, v38, v98, 0
    v_dot2_f32_bf16 v69, v38, v102, 0
    v_dot2_f32_bf16 v70, v39, v99, 0
    v_dot2_f32_bf16 v71, v39, v103, 0
    v_mfma_f32_32x32x16_bf16 v[104:119], a[32:35], v[40:43], v[104:119]
    v_cvt_pk_bf16_f32 v48, v48, v49
    v_cvt_pk_bf16_f32 v49, v50, v51
    v_cvt_pk_bf16_f32 v50, v52, v53
    v_cvt_pk_bf16_f32 v51, v54, v55
    v_cvt_pk_bf16_f32 v56, v56, v57
    v_cvt_pk_bf16_f32 v57, v58, v59
    v_mfma_f32_32x32x16_bf16 v[104:119], a[36:39], v[48:51], v[104:119]
    v_cvt_pk_bf16_f32 v58, v60, v61
    v_cvt_pk_bf16_f32 v59, v62, v63
    v_cvt_pk_bf16_f32 v64, v64, v65
    v_cvt_pk_bf16_f32 v65, v66, v67
    v_cvt_pk_bf16_f32 v66, v68, v69
    v_cvt_pk_bf16_f32 v67, v70, v71
    v_mfma_f32_32x32x16_bf16 v[104:119], a[40:43], v[56:59], v[104:119]
    ds_read_b64_tr_b16 v[72:73], v5 offset:8448
    ds_read_b64_tr_b16 v[74:75], v5 offset:8960
    ds_write_b16 v17, v19 offset:12112
    v_lshl_add_u32 v17, v15, 2, v9
    v_and_b32 v18, s36, v13
    v_mfma_f32_32x32x16_bf16 v[104:119], a[44:47], v[64:67], v[104:119]
    s_nop 0
    ds_read_b64_tr_b16 v[76:77], v5 offset:8480
    ds_read_b64_tr_b16 v[78:79], v5 offset:8992
    ds_read_b64_tr_b16 v[80:81], v5 offset:8512
    ds_read_b64_tr_b16 v[82:83], v5 offset:9024
    ds_read_b64_tr_b16 v[84:85], v5 offset:8544
    ds_read_b64_tr_b16 v[86:87], v5 offset:9056
    v_mfma_f32_32x32x16_bf16 v[120:135], v[156:159], a[80:83], 0
    ds_read_b128 v[88:91], v10 offset:12112
    ds_read_b32 v13, v6 offset:640
    ds_read_b128 v[164:167], v7 offset:768
    ds_read_b128 a[80:83], v16
    v_exp_f32 v104, v104
    v_mfma_f32_32x32x16_bf16 v[120:135], a[16:19], v[24:27], v[120:135]
    v_exp_f32 v105, v105
    v_exp_f32 v106, v106
    v_exp_f32 v107, v107
    v_mfma_f32_32x32x16_bf16 v[120:135], a[20:23], v[28:31], v[120:135]
    v_exp_f32 v108, v108
    v_exp_f32 v109, v109
    v_exp_f32 v110, v110
    v_mfma_f32_32x32x16_bf16 v[120:135], a[24:27], v[32:35], v[120:135]
    v_exp_f32 v111, v111
    v_exp_f32 v112, v112
    v_exp_f32 v113, v113
    v_mfma_f32_32x32x16_bf16 v[120:135], a[28:31], v[36:39], v[120:135]
    v_exp_f32 v114, v114
    v_exp_f32 v115, v115
    v_exp_f32 v116, v116
    v_exp_f32 v117, v117
    v_exp_f32 v118, v118
    v_exp_f32 v119, v119
    v_pk_add_f32 v[104:105], v[104:105], 1.0 op_sel_hi:[1,0]
    v_pk_add_f32 v[106:107], v[106:107], 1.0 op_sel_hi:[1,0]
    v_pk_add_f32 v[108:109], v[108:109], 1.0 op_sel_hi:[1,0]
    v_pk_add_f32 v[110:111], v[110:111], 1.0 op_sel_hi:[1,0]
    v_pk_add_f32 v[112:113], v[112:113], 1.0 op_sel_hi:[1,0]
    v_pk_add_f32 v[114:115], v[114:115], 1.0 op_sel_hi:[1,0]
    v_pk_add_f32 v[116:117], v[116:117], 1.0 op_sel_hi:[1,0]
    v_pk_add_f32 v[118:119], v[118:119], 1.0 op_sel_hi:[1,0]
    v_mfma_f32_32x32x16_bf16 v[120:135], a[48:51], v[40:43], v[120:135]
    s_waitcnt lgkmcnt(0)
    v_rcp_f32 v104, v104
    v_rcp_f32 v105, v105
    v_rcp_f32 v106, v106
    v_mfma_f32_32x32x16_bf16 v[120:135], a[52:55], v[48:51], v[120:135]
    s_add_u32 m0, s34, 8448
    v_rcp_f32 v107, v107
    v_rcp_f32 v108, v108
    v_rcp_f32 v109, v109
    v_mfma_f32_32x32x16_bf16 v[120:135], a[56:59], v[56:59], v[120:135]
    v_rcp_f32 v110, v110
    v_rcp_f32 v111, v111
    v_rcp_f32 v112, v112
    v_mfma_f32_32x32x16_bf16 v[120:135], a[60:63], v[64:67], v[120:135]
    v_rcp_f32 v113, v113
    v_rcp_f32 v114, v114
    v_rcp_f32 v115, v115
    v_mfma_f32_16x16x32_bf16 v[136:139], v[72:75], v[88:91], v[136:139]
    v_rcp_f32 v116, v116
    v_mfma_f32_16x16x32_bf16 v[140:143], v[76:79], v[88:91], v[140:143]
    v_rcp_f32 v117, v117
    v_mfma_f32_16x16x32_bf16 v[144:147], v[80:83], v[88:91], v[144:147]
    v_rcp_f32 v118, v118
    v_mfma_f32_16x16x32_bf16 v[148:151], v[84:87], v[88:91], v[148:151]
    ds_read_b128 v[72:75], v23 offset:4224
    ds_read_b128 v[76:79], v23 offset:4352
    ds_read_b128 v[80:83], v23 offset:4256
    ds_read_b128 v[84:87], v23 offset:4384
    ds_read_b128 v[88:91], v23 offset:4288
    ds_read_b128 v[92:95], v23 offset:4416
    ds_read_b128 v[96:99], v23 offset:4320
    ds_read_b128 v[100:103], v23 offset:4448
    v_rcp_f32_e64 v119, v119
    v_cvt_pk_bf16_f32 v44, v104, v105
    v_cvt_pk_bf16_f32 v45, v106, v107
    v_cvt_pk_bf16_f32 v46, v108, v109
    v_cvt_pk_bf16_f32 v47, v110, v111
    v_cvt_pk_bf16_f32 v52, v112, v113
    v_cvt_pk_bf16_f32 v53, v114, v115
    v_cvt_pk_bf16_f32 v54, v116, v117
    v_cvt_pk_bf16_f32 v55, v118, v119
    v_exp_f32 v120, v120
    v_exp_f32 v121, v121
    v_exp_f32 v122, v122
    v_exp_f32 v123, v123
    v_exp_f32 v124, v124
    v_exp_f32 v125, v125
    v_exp_f32 v126, v126
    v_exp_f32 v127, v127
    v_exp_f32 v128, v128
    v_exp_f32 v129, v129
    v_exp_f32 v130, v130
    v_exp_f32 v131, v131
    v_exp_f32 v132, v132
    v_exp_f32 v133, v133
    v_exp_f32 v134, v134
    v_exp_f32 v135, v135
    v_pk_add_f32 v[120:121], v[120:121], 1.0 op_sel_hi:[1,0]
    v_pk_add_f32 v[122:123], v[122:123], 1.0 op_sel_hi:[1,0]
    v_pk_add_f32 v[124:125], v[124:125], 1.0 op_sel_hi:[1,0]
    v_pk_add_f32 v[126:127], v[126:127], 1.0 op_sel_hi:[1,0]
    v_pk_add_f32 v[128:129], v[128:129], 1.0 op_sel_hi:[1,0]
    v_pk_add_f32 v[130:131], v[130:131], 1.0 op_sel_hi:[1,0]
    v_pk_add_f32 v[132:133], v[132:133], 1.0 op_sel_hi:[1,0]
    v_pk_add_f32 v[134:135], v[134:135], 1.0 op_sel_hi:[1,0]
    v_rcp_f32 v120, v120
    v_rcp_f32 v121, v121
    v_rcp_f32 v122, v122
    v_rcp_f32 v123, v123
    v_rcp_f32 v124, v124
    v_mfma_f32_32x32x16_bf16 v[104:119], v[152:155], a[80:83], 0
    s_waitcnt vmcnt(0)
    ds_read_b128 v[24:27], v4 offset:4224
    ds_read_b128 v[28:31], v4 offset:4256
    ds_read_b128 v[32:35], v4 offset:4288
    ds_read_b128 v[36:39], v4 offset:4320
    v_rcp_f32 v125, v125
    v_rcp_f32 v126, v126
    v_mfma_f32_16x16x32_bf16 v[160:163], a[64:67], v[44:47], v[2:5]
    buffer_load_dwordx4 v168, s[24:27], 0 offen offset:0 nt lds
    buffer_load_dwordx4 v169, s[28:31], 0 offen offset:1056 nt lds
    buffer_load_dwordx4 v170, s[40:43], 0 offen offset:2112 nt lds
    buffer_load_dwordx4 v171, s[44:47], 0 offen offset:3168 nt lds
    v_mfma_f32_16x16x32_bf16 v[160:163], a[68:71], v[52:55], v[160:163]
    s_waitcnt lgkmcnt(3)
    v_rcp_f32 v127, v127
    v_mfma_f32_32x32x16_bf16 v[104:119], a[0:3], v[24:27], v[104:119]
    s_waitcnt lgkmcnt(2)
    v_rcp_f32 v128, v128
    v_cvt_pk_bf16_f32 v60, v120, v121
    v_cvt_pk_bf16_f32 v61, v122, v123
    v_cvt_pk_bf16_f32 v62, v124, v125
    v_cvt_pk_bf16_f32 v63, v126, v127
    v_mfma_f32_32x32x16_bf16 v[104:119], a[4:7], v[28:31], v[104:119]
    s_waitcnt lgkmcnt(0)
    v_rcp_f32 v129, v129
    v_rcp_f32 v130, v130
    v_rcp_f32 v131, v131
    v_mfma_f32_16x16x32_bf16 v[160:163], a[72:75], v[60:63], v[160:163]
    v_rcp_f32 v132, v132
    v_mfma_f32_32x32x16_bf16 v[104:119], a[8:11], v[32:35], v[104:119]
    v_rcp_f32 v133, v133
    v_rcp_f32 v134, v134
    v_rcp_f32 v135, v135
    v_mfma_f32_32x32x16_bf16 v[104:119], a[12:15], v[36:39], v[104:119]
    v_cvt_pk_bf16_f32 v68, v128, v129
    v_cvt_pk_bf16_f32 v69, v130, v131
    v_cvt_pk_bf16_f32 v70, v132, v133
    v_cvt_pk_bf16_f32 v71, v134, v135
    v_and_b32_e64 v15, s79, v13
    v_lshl_add_u32 v16, v15, 2, v8
    v_mfma_f32_16x16x32_bf16 v[160:163], a[76:79], v[68:71], v[160:163]
    v_mad_u32_u24 v23, v15, s37, v11
    v_and_or_b32 v164, v164, s22, v3
    v_and_or_b32 v165, v165, s22, v3
    v_and_or_b32 v166, v166, s22, v3
    v_and_or_b32 v167, v167, s22, v3
L_p4:
    v_dot2_f32_bf16 v40, v24, v72, 0
    v_dot2_f32_bf16 v41, v24, v76, 0
    v_dot2_f32_bf16 v42, v25, v73, 0
    v_dot2_f32_bf16 v43, v25, v77, 0
    v_dot2_f32_bf16 v44, v26, v74, 0
    v_dot2_f32_bf16 v45, v26, v78, 0
    v_dot2_f32_bf16 v46, v27, v75, 0
    v_dot2_f32_bf16 v47, v27, v79, 0
    v_mul_f32_e64 v19, v160, v18
    v_dot2_f32_bf16 v48, v28, v80, 0
    v_dot2_f32_bf16 v49, v28, v84, 0
    v_dot2_f32_bf16 v50, v29, v81, 0
    v_dot2_f32_bf16 v51, v29, v85, 0
    v_cvt_pk_bf16_f32 v19, v19, v19
    v_dot2_f32_bf16 v52, v30, v82, 0
    v_dot2_f32_bf16 v53, v30, v86, 0
    v_dot2_f32_bf16 v54, v31, v83, 0
    v_dot2_f32_bf16 v55, v31, v87, 0
    v_dot2_f32_bf16 v56, v32, v88, 0
    v_dot2_f32_bf16 v57, v32, v92, 0
    v_dot2_f32_bf16 v58, v33, v89, 0
    v_dot2_f32_bf16 v59, v33, v93, 0
    v_cvt_pk_bf16_f32 v40, v40, v41
    v_cvt_pk_bf16_f32 v41, v42, v43
    v_cvt_pk_bf16_f32 v42, v44, v45
    v_cvt_pk_bf16_f32 v43, v46, v47
    v_dot2_f32_bf16 v60, v34, v90, 0
    v_dot2_f32_bf16 v61, v34, v94, 0
    v_dot2_f32_bf16 v62, v35, v91, 0
    v_dot2_f32_bf16 v63, v35, v95, 0
    v_dot2_f32_bf16 v64, v36, v96, 0
    v_dot2_f32_bf16 v65, v36, v100, 0
    v_dot2_f32_bf16 v66, v37, v97, 0
    v_dot2_f32_bf16 v67, v37, v101, 0
    v_dot2_f32_bf16 v68, v38, v98, 0
    v_dot2_f32_bf16 v69, v38, v102, 0
    v_dot2_f32_bf16 v70, v39, v99, 0
    v_dot2_f32_bf16 v71, v39, v103, 0
    v_mfma_f32_32x32x16_bf16 v[104:119], a[32:35], v[40:43], v[104:119]
    v_cvt_pk_bf16_f32 v48, v48, v49
    v_cvt_pk_bf16_f32 v49, v50, v51
    v_cvt_pk_bf16_f32 v50, v52, v53
    v_cvt_pk_bf16_f32 v51, v54, v55
    v_cvt_pk_bf16_f32 v56, v56, v57
    v_cvt_pk_bf16_f32 v57, v58, v59
    v_mfma_f32_32x32x16_bf16 v[104:119], a[36:39], v[48:51], v[104:119]
    v_cvt_pk_bf16_f32 v58, v60, v61
    v_cvt_pk_bf16_f32 v59, v62, v63
    v_cvt_pk_bf16_f32 v64, v64, v65
    v_cvt_pk_bf16_f32 v65, v66, v67
    v_cvt_pk_bf16_f32 v66, v68, v69
    v_cvt_pk_bf16_f32 v67, v70, v71
    v_mfma_f32_32x32x16_bf16 v[104:119], a[40:43], v[56:59], v[104:119]
    ds_read_b64_tr_b16 v[72:73], v5 offset:0
    ds_read_b64_tr_b16 v[74:75], v5 offset:512
    ds_write_b16 v17, v19 offset:13200
    v_lshl_add_u32 v17, v14, 2, v9
    v_and_b32 v18, s36, v12
    v_mfma_f32_32x32x16_bf16 v[104:119], a[44:47], v[64:67], v[104:119]
    s_nop 0
    ds_read_b64_tr_b16 v[76:77], v5 offset:32
    ds_read_b64_tr_b16 v[78:79], v5 offset:544
    ds_read_b64_tr_b16 v[80:81], v5 offset:64
    ds_read_b64_tr_b16 v[82:83], v5 offset:576
    ds_read_b64_tr_b16 v[84:85], v5 offset:96
    ds_read_b64_tr_b16 v[86:87], v5 offset:608
    v_mfma_f32_32x32x16_bf16 v[120:135], v[156:159], a[80:83], 0
    ds_read_b128 v[88:91], v10 offset:13200
    ds_read_b32 v12, v6 offset:768
    ds_read_b128 v[168:171], v7 offset:896
    ds_read_b128 a[80:83], v16
    v_exp_f32 v104, v104
    v_mfma_f32_32x32x16_bf16 v[120:135], a[16:19], v[24:27], v[120:135]
    v_exp_f32 v105, v105
    v_exp_f32 v106, v106
    v_exp_f32 v107, v107
    v_mfma_f32_32x32x16_bf16 v[120:135], a[20:23], v[28:31], v[120:135]
    v_exp_f32 v108, v108
    v_exp_f32 v109, v109
    v_exp_f32 v110, v110
    v_mfma_f32_32x32x16_bf16 v[120:135], a[24:27], v[32:35], v[120:135]
    v_exp_f32 v111, v111
    v_exp_f32 v112, v112
    v_exp_f32 v113, v113
    v_mfma_f32_32x32x16_bf16 v[120:135], a[28:31], v[36:39], v[120:135]
    v_exp_f32 v114, v114
    v_exp_f32 v115, v115
    v_exp_f32 v116, v116
    v_exp_f32 v117, v117
    v_exp_f32 v118, v118
    v_exp_f32 v119, v119
    v_pk_add_f32 v[104:105], v[104:105], 1.0 op_sel_hi:[1,0]
    v_pk_add_f32 v[106:107], v[106:107], 1.0 op_sel_hi:[1,0]
    v_pk_add_f32 v[108:109], v[108:109], 1.0 op_sel_hi:[1,0]
    v_pk_add_f32 v[110:111], v[110:111], 1.0 op_sel_hi:[1,0]
    v_pk_add_f32 v[112:113], v[112:113], 1.0 op_sel_hi:[1,0]
    v_pk_add_f32 v[114:115], v[114:115], 1.0 op_sel_hi:[1,0]
    v_pk_add_f32 v[116:117], v[116:117], 1.0 op_sel_hi:[1,0]
    v_pk_add_f32 v[118:119], v[118:119], 1.0 op_sel_hi:[1,0]
    v_mfma_f32_32x32x16_bf16 v[120:135], a[48:51], v[40:43], v[120:135]
    s_waitcnt lgkmcnt(0)
    v_rcp_f32 v104, v104
    v_rcp_f32 v105, v105
    v_rcp_f32 v106, v106
    v_mfma_f32_32x32x16_bf16 v[120:135], a[52:55], v[48:51], v[120:135]
    s_add_u32 m0, s34, 0
    v_rcp_f32 v107, v107
    v_rcp_f32 v108, v108
    v_rcp_f32 v109, v109
    v_mfma_f32_32x32x16_bf16 v[120:135], a[56:59], v[56:59], v[120:135]
    v_rcp_f32 v110, v110
    v_rcp_f32 v111, v111
    v_rcp_f32 v112, v112
    v_mfma_f32_32x32x16_bf16 v[120:135], a[60:63], v[64:67], v[120:135]
    v_rcp_f32 v113, v113
    v_rcp_f32 v114, v114
    v_rcp_f32 v115, v115
    v_mfma_f32_16x16x32_bf16 v[136:139], v[72:75], v[88:91], v[136:139]
    v_rcp_f32 v116, v116
    v_mfma_f32_16x16x32_bf16 v[140:143], v[76:79], v[88:91], v[140:143]
    v_rcp_f32 v117, v117
    v_mfma_f32_16x16x32_bf16 v[144:147], v[80:83], v[88:91], v[144:147]
    v_rcp_f32_e64 v118, v118
    v_mfma_f32_16x16x32_bf16 v[148:151], v[84:87], v[88:91], v[148:151]
    ds_read_b128 v[72:75], v23 offset:4224
    ds_read_b128 v[76:79], v23 offset:4352
    ds_read_b128 v[80:83], v23 offset:4256
    ds_read_b128 v[84:87], v23 offset:4384
    ds_read_b128 v[88:91], v23 offset:4288
    ds_read_b128 v[92:95], v23 offset:4416
    ds_read_b128 v[96:99], v23 offset:4320
    ds_read_b128 v[100:103], v23 offset:4448
    v_rcp_f32_e64 v119, v119
    v_cvt_pk_bf16_f32 v44, v104, v105
    v_cvt_pk_bf16_f32 v45, v106, v107
    v_cvt_pk_bf16_f32 v46, v108, v109
    v_cvt_pk_bf16_f32 v47, v110, v111
    v_cvt_pk_bf16_f32 v52, v112, v113
    v_cvt_pk_bf16_f32 v53, v114, v115
    v_cvt_pk_bf16_f32 v54, v116, v117
    v_cvt_pk_bf16_f32 v55, v118, v119
    v_exp_f32 v120, v120
    v_exp_f32 v121, v121
    v_exp_f32 v122, v122
    v_exp_f32 v123, v123
    v_exp_f32 v124, v124
    v_exp_f32 v125, v125
    v_exp_f32 v126, v126
    v_exp_f32 v127, v127
    v_exp_f32 v128, v128
    v_exp_f32 v129, v129
    v_exp_f32 v130, v130
    v_exp_f32 v131, v131
    v_exp_f32 v132, v132
    v_exp_f32 v133, v133
    v_exp_f32 v134, v134
    v_exp_f32 v135, v135
    v_pk_add_f32 v[120:121], v[120:121], 1.0 op_sel_hi:[1,0]
    v_pk_add_f32 v[122:123], v[122:123], 1.0 op_sel_hi:[1,0]
    v_pk_add_f32 v[124:125], v[124:125], 1.0 op_sel_hi:[1,0]
    v_pk_add_f32 v[126:127], v[126:127], 1.0 op_sel_hi:[1,0]
    v_pk_add_f32 v[128:129], v[128:129], 1.0 op_sel_hi:[1,0]
    v_pk_add_f32 v[130:131], v[130:131], 1.0 op_sel_hi:[1,0]
    v_pk_add_f32 v[132:133], v[132:133], 1.0 op_sel_hi:[1,0]
    v_pk_add_f32 v[134:135], v[134:135], 1.0 op_sel_hi:[1,0]
    v_rcp_f32 v120, v120
    v_rcp_f32 v121, v121
    v_rcp_f32 v122, v122
    v_rcp_f32 v123, v123
    v_rcp_f32 v124, v124
    v_mfma_f32_32x32x16_bf16 v[104:119], v[152:155], a[80:83], 0
    s_waitcnt vmcnt(0)
    ds_read_b128 v[24:27], v4 offset:8448
    ds_read_b128 v[28:31], v4 offset:8480
    ds_read_b128 v[32:35], v4 offset:8512
    ds_read_b128 v[36:39], v4 offset:8544
    v_rcp_f32 v125, v125
    v_rcp_f32 v126, v126
    v_mfma_f32_16x16x32_bf16 v[160:163], a[64:67], v[44:47], v[2:5]
    buffer_load_dwordx4 v164, s[24:27], 0 offen offset:0 nt lds
    buffer_load_dwordx4 v165, s[28:31], 0 offen offset:1056 nt lds
    buffer_load_dwordx4 v166, s[40:43], 0 offen offset:2112 nt lds
    buffer_load_dwordx4 v167, s[44:47], 0 offen offset:3168 nt lds
    v_mfma_f32_16x16x32_bf16 v[160:163], a[68:71], v[52:55], v[160:163]
    s_waitcnt lgkmcnt(3)
    v_rcp_f32 v127, v127
    v_mfma_f32_32x32x16_bf16 v[104:119], a[0:3], v[24:27], v[104:119]
    s_waitcnt lgkmcnt(2)
    v_rcp_f32 v128, v128
    v_cvt_pk_bf16_f32 v60, v120, v121
    v_cvt_pk_bf16_f32 v61, v122, v123
    v_cvt_pk_bf16_f32 v62, v124, v125
    v_cvt_pk_bf16_f32 v63, v126, v127
    v_mfma_f32_32x32x16_bf16 v[104:119], a[4:7], v[28:31], v[104:119]
    s_waitcnt lgkmcnt(0)
    v_rcp_f32 v129, v129
    v_rcp_f32 v130, v130
    v_rcp_f32 v131, v131
    v_mfma_f32_16x16x32_bf16 v[160:163], a[72:75], v[60:63], v[160:163]
    v_rcp_f32 v132, v132
    v_mfma_f32_32x32x16_bf16 v[104:119], a[8:11], v[32:35], v[104:119]
    v_rcp_f32 v133, v133
    v_rcp_f32 v134, v134
    v_rcp_f32 v135, v135
    v_mfma_f32_32x32x16_bf16 v[104:119], a[12:15], v[36:39], v[104:119]
    v_cvt_pk_bf16_f32 v68, v128, v129
    v_cvt_pk_bf16_f32 v69, v130, v131
    v_cvt_pk_bf16_f32 v70, v132, v133
    v_cvt_pk_bf16_f32 v71, v134, v135
    v_and_b32_e64 v14, s79, v12
    v_lshl_add_u32 v16, v14, 2, v8
    v_mfma_f32_16x16x32_bf16 v[160:163], a[76:79], v[68:71], v[160:163]
    v_mad_u32_u24 v23, v14, s37, v11
    v_and_or_b32 v168, v168, s22, v3
    v_and_or_b32 v169, v169, s22, v3
    v_and_or_b32 v170, v170, s22, v3
    v_and_or_b32 v171, v171, s22, v3
    s_branch L_p5
    s_endpgm
.section .rodata,"a"
.p2align 6
.amdhsa_kernel standalone__sequential_behavior_din__recsys_kernel
  .amdhsa_next_free_vgpr 256
  .amdhsa_next_free_sgpr 100
  .amdhsa_accum_offset 172
  .amdhsa_group_segment_fixed_size 0
  .amdhsa_kernarg_size 80
  .amdhsa_user_sgpr_count 2
  .amdhsa_user_sgpr_kernarg_segment_ptr 1
  .amdhsa_system_sgpr_workgroup_id_x 1
  .amdhsa_float_denorm_mode_32 3
.end_amdhsa_kernel
```
